```python
import torch

def _softmax(x, axis=-1):
    return torch.softmax(x, dim=axis)
def _gelu(x):
    return torch.nn.functional.gelu(x, approximate="tanh")
def _silu(x):
    return torch.nn.functional.silu(x)
def _sigmoid(x):
    return torch.sigmoid(x)
def _layernorm(x, axis=-1, eps=1e-5):
    m = x.mean(dim=axis, keepdim=True)
    v = x.var(dim=axis, keepdim=True, unbiased=False)
    return (x - m) / torch.sqrt(v + eps)
def _scatter_add(tgt, idx, src, axis=0):
    return tgt.clone().index_add_(axis, idx, src)
def _segment_sum(src, seg, n):
    out = torch.zeros((n,) + src.shape[1:], dtype=src.dtype)
    return out.index_add_(0, seg, src)
def _pad(x, pw):
    flat = tuple(v for pair in reversed(pw) for v in pair)
    return torch.nn.functional.pad(x, flat)

kernel_name = 'gated_mix__mha_block__mha_block__prompt'

def setup_inputs():

    _w = (lambda a: (lambda t: t.to(torch.bfloat16) if t.is_floating_point() else t)(torch.as_tensor(a)))
    def _A_setup():
        B, S, D, H = 1, 2048, 576, 32
        return {
            "x": _w((lambda *s: torch.randn(*s, dtype=torch.bfloat16) * 0.05)(B, S, D)),
            "wqkv": _w((lambda *s: torch.randn(*s, dtype=torch.bfloat16) * 0.8)(D, 3 * D)),
            "wo": _w((lambda *s: torch.randn(*s, dtype=torch.bfloat16) * 0.05)(D, D)),
        }
    _A_in = _A_setup()

    def _B_setup():
        B, S, D, H = 1, 2048, 576, 32
        return {
            "x": _w((lambda *s: torch.randn(*s, dtype=torch.bfloat16) * 0.05)(B, S, D)),
            "wqkv": _w((lambda *s: torch.randn(*s, dtype=torch.bfloat16) * 0.8)(D, 3 * D)),
            "wo": _w((lambda *s: torch.randn(*s, dtype=torch.bfloat16) * 0.05)(D, D)),
        }
    _B_in = _B_setup()

    return {
        "A_x": _A_in["x"],
        "A_wqkv": _A_in["wqkv"],
        "A_wo": _A_in["wo"],
        "B_x": _B_in["x"],
        "B_wqkv": _B_in["wqkv"],
        "B_wo": _B_in["wo"],
        "gate_w": _w((lambda *s: torch.randn(*s, dtype=torch.bfloat16) * 0.05)(576) * 16.0),
    }

def reference(A_x, A_wqkv, A_wo, B_x, B_wqkv, B_wo, gate_w):
    def _A_ref(x, wqkv, wo):
        B, S, D = x.shape
        H = 32
        Dh = D // H
        qkv = (lambda x, *d: x.permute(*d))((x @ wqkv).reshape(B, S, 3, H, Dh), 2, 0, 3, 1, 4)
        q, k, v = qkv[0], qkv[1], qkv[2]
        scores = torch.einsum("bhqd,bhkd->bhqk", q, k) * (Dh ** -0.5)
        p = _softmax(scores, axis=-1)
        o = torch.einsum("bhqk,bhkd->bhqd", p, v)
        return (lambda x, *d: x.permute(*d))(o, 0, 2, 1, 3).reshape(B, S, D) @ wo

    def _B_ref(x, wqkv, wo):
        B, S, D = x.shape
        H = 32
        Dh = D // H
        qkv = (lambda x, *d: x.permute(*d))((x @ wqkv).reshape(B, S, 3, H, Dh), 2, 0, 3, 1, 4)
        q, k, v = qkv[0], qkv[1], qkv[2]
        scores = torch.einsum("bhqd,bhkd->bhqk", q, k) * (Dh ** -0.5)
        p = _softmax(scores, axis=-1)
        o = torch.einsum("bhqk,bhkd->bhqd", p, v)
        return (lambda x, *d: x.permute(*d))(o, 0, 2, 1, 3).reshape(B, S, D) @ wo

    x = A_x
    g = _sigmoid((x * gate_w).sum(-1, keepdims=True))
    a = _A_ref(x, A_wqkv, A_wo)
    b = _B_ref(x, B_wqkv, B_wo)
    return g * a + (1 - g) * b
```

```asm
; @launch grid=(256,1,1) block=(512,1,1) lds=163840
.amdgcn_target "amdgcn-amd-amdhsa--gfx950"
.text
.globl gated_mix__mha_block__mha_block__prompt_kernel
.p2align 8
.type gated_mix__mha_block__mha_block__prompt_kernel,@function
gated_mix__mha_block__mha_block__prompt_kernel:
    s_cmp_ge_u32 s2, 256
    s_cbranch_scc1 k_end
    s_load_dwordx2 s[8:9], s[0:1], 0
    s_bfe_u32 s37, s2, 65538
    s_mul_i32 s37, s37, 24
    s_add_u32 s38, s37, 8
    s_add_u32 s37, s37, 16
    s_load_dwordx2 s[12:13], s[0:1], s38
    s_load_dwordx2 s[20:21], s[0:1], 48
    s_load_dwordx2 s[28:29], s[0:1], 72
    s_load_dwordx2 s[24:25], s[0:1], 64
    s_load_dwordx2 s[84:85], s[0:1], 56
    s_load_dwordx2 s[16:17], s[0:1], s37
    v_lshrrev_b32 v1, 6, v0
    v_and_b32 v0, 63, v0
    s_bfe_u32 s38, s2, 131075
    v_readfirstlane_b32 s49, v1
    s_lshr_b32 s39, s2, 5
    s_and_b32 s34, s2, 1
    s_lshl_b32 s34, s34, 2
    s_add_u32 s34, s34, s38
    s_and_b32 s33, s2, 6
    s_lshl_b32 s33, s33, 2
    s_add_u32 s33, s33, s39
    s_and_b32 s32, s49, 3
    s_lshr_b32 s93, s32, 1
    s_and_b32 s94, s32, 1
    s_bfe_u32 s78, s2, 65541
    s_lshl_b32 s78, s78, 1
    s_bfe_u32 s39, s2, 65542
    s_or_b32 s78, s78, s39
    s_cmp_ge_u32 s49, 4
    s_cbranch_scc0 k_compute
    s_setprio 2
    s_lshr_b32 s36, s2, 7
    s_lshl_b32 s38, s38, 1
    s_add_u32 s36, s36, s38
    s_and_b32 s38, s2, 7
    s_add_u32 s36, s36, s38
    s_sub_u32 s38, s36, 9
    s_cselect_b32 s36, s36, s38
    v_lshrrev_b32 v10, 3, v0
    v_mul_u32_u24 v10, 1152, v10
    v_and_b32 v11, 7, v0
    v_lshrrev_b32 v12, 4, v0
    v_xor_b32 v11, v11, v12
    v_lshlrev_b32 v11, 4, v11
    v_xor_b32 v12, 64, v11
    v_add_u32 v24, v10, v11
    v_add_u32 v25, v10, v12
    v_add_u32 v25, 8192, v25
    s_lshl_b32 s44, s34, 4
    s_lshl_b32 s37, s93, 3
    s_add_u32 s44, s44, s37
    s_add_u32 s44, s44, s94
    s_mul_i32 s44, s44, 18432
    s_lshl_b32 s43, s36, 7
    s_lshl_b32 s45, s32, 11
    s_add_u32 s45, s45, 98304
    s_add_u32 s41, s44, s43
    s_mov_b32 s76, s45
    s_xor_b32 s56, s78, 0
    s_mul_i32 s56, s56, 36864
    s_xor_b32 s57, s78, 1
    s_mul_i32 s57, s57, 36864
    s_xor_b32 s58, s78, 2
    s_mul_i32 s58, s58, 36864
    s_xor_b32 s59, s78, 3
    s_mul_i32 s59, s59, 36864
    s_mov_b32 s10, 2359296
    s_mov_b32 s11, 0x00020000
    s_mov_b32 s14, 1990656
    s_mov_b32 s15, 0x00020000
    s_mov_b32 s22, 1152
    s_mov_b32 s23, 0x00020000
    s_waitcnt lgkmcnt(0)
    s_mov_b32 m0, s76
    s_add_u32 s37, s41, s56
    buffer_load_dwordx4 v24, s[8:11], s37 offen lds
    buffer_load_dwordx4 v25, s[8:11], s37 offen offset:1024 lds
    s_add_u32 s76, s76, 8192
    s_cmp_ge_u32 s76, 155648
    s_cselect_b32 s76, s45, s76
    v_lshrrev_b32 v10, 4, v0
    v_lshlrev_b32 v11, 1, v10
    v_and_b32 v12, 15, v0
    v_xor_b32 v11, v11, v12
    s_mov_b32 s37, 135296
    v_mul_u32_u24 v10, 3456, v10
    v_mul_u32_u24 v12, 52, v11
    v_lshrrev_b32 v12, 8, v12
    v_mul_u32_u24 v12, 1072, v12
    v_lshl_add_u32 v12, v11, 4, v12
    v_lshrrev_b32 v13, v11, s37
    v_and_b32 v13, 8, v13
    v_sub_u32 v12, v12, v13
    v_add_u32 v26, v10, v12
    v_xor_b32 v11, 8, v11
    v_mul_u32_u24 v12, 52, v11
    v_lshrrev_b32 v12, 8, v12
    v_mul_u32_u24 v12, 1072, v12
    v_lshl_add_u32 v12, v11, 4, v12
    v_lshrrev_b32 v13, v11, s37
    v_and_b32 v13, 8, v13
    v_sub_u32 v12, v12, v13
    v_add_u32 v27, v10, v12
    v_lshlrev_b32 v7, 4, v0
    s_mul_i32 s37, s32, 55296
    s_and_b32 s38, s33, 15
    s_mul_i32 s38, s38, 72
    s_add_u32 s54, s37, s38
    s_mul_i32 s62, s36, 221184
    s_add_u32 s63, s54, s62
    s_lshl_b32 s55, s32, 12
    s_lshl_b32 s39, s32, 11
    s_add_u32 s39, s39, 155648
    s_mov_b32 s52, 3758063615
    s_mov_b32 s53, 4261410815
    s_mov_b32 s64, 4292870015
    s_mov_b32 s65, 4294836215
    s_mov_b32 m0, s39
    s_nop 0
    buffer_load_dwordx4 v7, s[20:23], 0 offen lds
    s_mov_b64 exec, 0xff
    buffer_load_dwordx4 v7, s[20:23], 0 offen offset:1024 lds
    s_mov_b64 exec, -1
    s_add_u32 m0, s55, 0
    s_add_u32 s37, s63, 0
    s_add_u32 s38, s63, 12800
    s_mov_b64 exec, s[52:53]
    buffer_load_dwordx4 v26, s[12:15], s37 offen lds
    buffer_load_dwordx4 v26, s[12:15], s38 offen offset:1024 lds
    s_mov_b64 exec, -1
    s_add_u32 m0, s55, 2048
    s_add_u32 s37, s63, 27648
    s_add_u32 s38, s63, 40448
    s_mov_b64 exec, s[64:65]
    buffer_load_dwordx4 v27, s[12:15], s37 offen lds
    buffer_load_dwordx4 v27, s[12:15], s38 offen offset:1024 lds
    s_mov_b64 exec, -1
    s_add_u32 s62, s62, 221184
    s_cmp_ge_u32 s62, 1990656
    s_cselect_b32 s62, 0, s62
    s_add_u32 s63, s54, s62
    s_add_u32 s55, s55, 16384
    s_sub_u32 s37, s55, 49152
    s_cmp_ge_u32 s55, 49152
    s_cselect_b32 s55, s37, s55
    s_mov_b32 m0, s76
    s_add_u32 s37, s41, s57
    buffer_load_dwordx4 v24, s[8:11], s37 offen lds
    buffer_load_dwordx4 v25, s[8:11], s37 offen offset:1024 lds
    s_add_u32 s76, s76, 8192
    s_cmp_ge_u32 s76, 155648
    s_cselect_b32 s76, s45, s76
    s_mov_b32 s42, s55
    s_mov_b32 s30, 18874368
    s_mov_b32 s31, 0x00020000
    s_mov_b32 s86, 2359296
    s_mov_b32 s87, 0x00020000
    s_mov_b32 s26, 256
    s_mov_b32 s27, 0x00020000
    s_mov_b32 s18, 663552
    s_mov_b32 s19, 0x00020000
    s_lshl_b32 s79, s33, 1
    s_add_u32 s79, s79, s93
    s_mul_i32 s47, s79, 151552
    s_lshl_b32 s37, s32, 5
    s_add_u32 s37, s37, s39
    v_lshl_add_u32 v8, v0, 1, s37
    v_and_b32 v11, 3, v0
    v_lshlrev_b32 v11, 1, v11
    v_and_b32 v12, 8, v0
    v_or_b32 v11, v11, v12
    v_xor_b32 v11, 15, v11
    v_lshlrev_b32 v11, 4, v11
    v_lshl_add_u32 v11, v0, 8, v11
    s_lshl_b32 s77, s36, 7
    v_mov_b32 v10, 163328
    v_mov_b32 v20, 0
    v_mov_b32 v21, 0
    v_mov_b32 v22, 0
    v_mov_b32 v23, 0
    ds_write_b128 v10, v[20:23]
    ds_write_b128 v10, v[20:23] offset:16
    ds_write_b128 v10, v[20:23] offset:32
    v_mul_u32_u24 v84, 57, v0
    v_lshrrev_b32 v84, 10, v84
    v_mul_u32_u24 v85, 18, v84
    v_sub_u32 v85, v0, v85
    v_lshlrev_b32 v85, 4, v85
    s_and_b32 s37, s34, 1
    s_lshl_b32 s37, s37, 1
    s_mul_i32 s38, s32, 3
    s_add_u32 s37, s37, s38
    v_add_u32 v84, s37, v84
    v_mul_u32_u24 v28, 1152, v84
    v_add_u32 v28, v28, v85
    v_cmp_le_u32 vcc, 6, v84
    v_add_u32 v86, 13824, v28
    v_subrev_u32 v87, 6912, v28
    v_cndmask_b32 v29, v86, v87, vcc
    s_mul_i32 s37, s93, 75776
    s_mul_i32 s38, s94, 5120
    s_add_u32 s37, s37, s38
    v_add_u32 v30, s37, v7
    s_lshl_b32 s37, s33, 2
    v_mov_b32 v17, s37
    s_lshl_b32 s37, s33, 12
    s_lshl_b32 s40, s93, 7
    s_add_u32 s37, s37, s40
    s_add_u32 s37, s37, 17563648
    v_and_b32 v16, 1, v0
    v_lshl_add_u32 v16, v16, 2, s37
    v_lshrrev_b32 v84, 1, v0
    v_lshl_add_u32 v16, v84, 8, v16
    v_mov_b32 v18, 163328
    v_mov_b32 v19, 1
    v_mov_b32 v31, 0x100
    v_lshlrev_b32 v79, 2, v0
    v_bfe_u32 v84, v0, 2, 3
    v_mul_u32_u24 v84, 288, v84
    v_and_b32 v85, 3, v0
    v_lshlrev_b32 v85, 3, v85
    v_add_u32 v85, 151552, v85
    v_and_b32 v86, 32, v0
    v_add3_u32 v77, v84, v85, v86
    s_lshl_b32 s37, s32, 6
    v_add_u32 v76, s37, v77
    v_bfe_u32 v84, v0, 2, 2
    v_mul_u32_u24 v84, 288, v84
    v_lshrrev_b32 v86, 4, v0
    v_lshlrev_b32 v86, 5, v86
    v_add3_u32 v84, v84, v85, v86
    s_lshl_b32 s37, s32, 7
    v_add_u32 v78, s37, v84
    v_mov_b32 v80, 4294967295
    v_mov_b32 v81, 4294967295
    v_mov_b32 v82, 4294967295
    v_mov_b32 v83, 4294967295
    s_and_b32 s37, s79, 7
    s_mul_i32 s37, s37, 448
    s_sub_u32 s37, 3584, s37
    v_lshrrev_b32 v84, 5, v0
    v_mul_u32_u24 v84, s37, v84
    v_add_u32 v88, v84, v7
    s_and_b32 s88, s2, 7
    s_lshr_b32 s37, s2, 5
    s_lshl_b32 s37, s37, 3
    s_add_u32 s88, s88, s37
    s_lshr_b32 s89, s2, 3
    s_and_b32 s89, s89, 3
    s_lshl_b32 s90, s88, 7
    s_lshl_b32 s40, s32, 3
    s_add_u32 s90, s90, s40
    s_mul_i32 s90, s90, 576
    s_add_u32 s90, s90, 10485760
    s_lshl_b32 s91, s89, 6
    s_add_u32 s91, s91, s40
    s_mul_i32 s91, s91, 4608
    s_add_u32 s91, s91, 15728640
    s_lshl_b32 s92, s89, 3
    s_add_u32 s92, s92, s32
    s_mul_i32 s92, s92, 4608
    s_add_u32 s92, s92, 17301504
    s_mul_i32 s74, s93, 75776
    s_mul_i32 s40, s94, 9216
    s_add_u32 s74, s74, s40
    s_add_u32 s74, s74, 56832
    s_mul_i32 s75, s32, 9216
    s_add_u32 s75, s75, 94720
    s_add_u32 s40, s89, 0
    s_and_b32 s40, s40, 1
    s_mul_i32 s66, s40, 18432
    s_add_u32 s66, s66, s90
    s_add_u32 s68, s66, 36864
    s_mul_i32 s70, s40, 147456
    s_add_u32 s70, s70, s91
    s_add_u32 s40, s89, 1
    s_and_b32 s40, s40, 1
    s_mul_i32 s67, s40, 18432
    s_add_u32 s67, s67, s90
    s_add_u32 s69, s67, 36864
    s_mul_i32 s71, s40, 147456
    s_add_u32 s71, s71, s91
    v_and_b32 v84, 15, v0
    v_lshrrev_b32 v85, 5, v0
    v_bfe_u32 v86, v0, 4, 1
    v_mul_u32_u24 v4, 4608, v85
    v_lshl_add_u32 v4, v86, 8, v4
    v_lshl_add_u32 v4, v84, 4, v4
    v_xor_b32 v85, s89, v85
    v_and_b32 v85, 1, v85
    v_lshl_add_u32 v86, v85, 3, v86
    v_mul_u32_u24 v5, 2304, v86
    v_lshl_add_u32 v5, v84, 4, v5
    v_and_b32 v84, 15, v0
    v_lshrrev_b32 v85, 5, v0
    v_bfe_u32 v86, v0, 4, 1
    v_lshlrev_b32 v2, 4, v0
    v_mul_u32_u24 v3, 4608, v85
    v_lshl_add_u32 v3, v86, 8, v3
    v_lshl_add_u32 v3, v84, 2, v3
    v_add_u32 v252, s75, v2
    v_add_u32 v2, s74, v2
    v_lshrrev_b32 v85, 4, v0
    v_mul_u32_u24 v6, 592, v84
    v_lshl_add_u32 v6, v85, 4, v6
    s_cmp_eq_u32 s32, 3
    s_cselect_b32 s40, 4, s32
    s_mul_i32 s40, s40, 18944
    v_add_u32 v6, s40, v6
    v_lshlrev_b32 v248, 3, v0
    v_add_u32 v248, 4096, v248
    v_add_u32 v253, s75, v248
    v_add_u32 v248, s74, v248
    s_lshl_b32 s40, s32, 2
    s_add_u32 s40, s40, 163360
    v_mov_b32 v251, s40
    v_and_b32 v1, 7, v0
    v_lshlrev_b32 v249, 6, v1
    v_add_u32 v249, 4096, v249
    s_and_b32 s40, s89, 1
    v_bfe_u32 v1, v0, 3, 2
    v_xor_b32 v1, s40, v1
    v_mul_u32_u24 v1, 18432, v1
    v_add_u32 v249, v249, v1
    v_mov_b32 v250, 163348
    v_mov_b32 v188, 0
    v_mov_b32 v189, 0
    v_mov_b32 v190, 0
    v_mov_b32 v191, 0
    v_mov_b32 v192, 0
    v_mov_b32 v193, 0
    v_mov_b32 v194, 0
    v_mov_b32 v195, 0
    v_mov_b32 v196, 0
    v_mov_b32 v197, 0
    v_mov_b32 v198, 0
    v_mov_b32 v199, 0
    v_mov_b32 v200, 0
    v_mov_b32 v201, 0
    v_mov_b32 v202, 0
    v_mov_b32 v203, 0
    v_mov_b32 v204, 0
    v_mov_b32 v205, 0
    v_mov_b32 v206, 0
    v_mov_b32 v207, 0
    v_mov_b32 v208, 0
    v_mov_b32 v209, 0
    v_mov_b32 v210, 0
    v_mov_b32 v211, 0
    v_mov_b32 v212, 0
    v_mov_b32 v213, 0
    v_mov_b32 v214, 0
    v_mov_b32 v215, 0
    v_mov_b32 v216, 0
    v_mov_b32 v217, 0
    v_mov_b32 v218, 0
    v_mov_b32 v219, 0
    v_mov_b32 v220, 0
    v_mov_b32 v221, 0
    v_mov_b32 v222, 0
    v_mov_b32 v223, 0
    v_mov_b32 v224, 0
    v_mov_b32 v225, 0
    v_mov_b32 v226, 0
    v_mov_b32 v227, 0
    s_sub_u32 s40, s42, 16384
    s_waitcnt vmcnt(6)
    v_add_u32 v10, s77, v8
    s_mov_b64 exec, 0xffff
    ds_read_u16 v14, v10
    v_add_u32 v10, s40, v11
    s_add_u32 s77, s77, 128
    s_cmp_ge_u32 s77, 1152
    s_cselect_b32 s77, 0, s77
    s_waitcnt lgkmcnt(0)
    ds_write2_b32 v10, v14, v14 offset0:0 offset1:1
    s_mov_b64 exec, -1
    v_add_u32 v10, s77, v8
    s_mov_b64 exec, 0xffff
    ds_read_u16 v14, v10
    v_add_u32 v10, s42, v11
    s_add_u32 s77, s77, 128
    s_cmp_ge_u32 s77, 1152
    s_cselect_b32 s77, 0, s77
    s_waitcnt lgkmcnt(0)
    ds_write2_b32 v10, v14, v14 offset0:0 offset1:1
    s_mov_b64 exec, -1
    s_waitcnt vmcnt(2) lgkmcnt(0)
    s_barrier
    s_mov_b32 m0, s76
    s_add_u32 s37, s41, s58
    buffer_load_dwordx4 v24, s[8:11], s37 offen lds
    buffer_load_dwordx4 v25, s[8:11], s37 offen offset:1024 lds
    s_add_u32 s76, s76, 8192
    s_cmp_ge_u32 s76, 155648
    s_cselect_b32 s76, s45, s76
    s_add_u32 m0, s55, 0
    s_add_u32 s37, s63, 0
    s_add_u32 s38, s63, 12800
    s_mov_b64 exec, s[52:53]
    buffer_load_dwordx4 v26, s[12:15], s37 offen lds
    buffer_load_dwordx4 v26, s[12:15], s38 offen offset:1024 lds
    s_mov_b64 exec, -1
    s_add_u32 m0, s55, 2048
    s_add_u32 s37, s63, 27648
    s_add_u32 s38, s63, 40448
    s_mov_b64 exec, s[64:65]
    buffer_load_dwordx4 v27, s[12:15], s37 offen lds
    buffer_load_dwordx4 v27, s[12:15], s38 offen offset:1024 lds
    s_mov_b64 exec, -1
    s_add_u32 s62, s62, 221184
    s_cmp_ge_u32 s62, 1990656
    s_cselect_b32 s62, 0, s62
    s_add_u32 s63, s54, s62
    s_add_u32 s55, s55, 16384
    s_sub_u32 s37, s55, 49152
    s_cmp_ge_u32 s55, 49152
    s_cselect_b32 s55, s37, s55
    s_mov_b32 m0, s76
    s_add_u32 s37, s41, s59
    buffer_load_dwordx4 v24, s[8:11], s37 offen lds
    buffer_load_dwordx4 v25, s[8:11], s37 offen offset:1024 lds
    s_add_u32 s76, s76, 8192
    s_cmp_ge_u32 s76, 155648
    s_cselect_b32 s76, s45, s76
    s_add_u32 s43, s43, 128
    s_cmp_ge_u32 s43, 1152
    s_cselect_b32 s43, 0, s43
    s_add_u32 s41, s44, s43
    s_mov_b32 m0, s76
    s_add_u32 s37, s41, s56
    buffer_load_dwordx4 v24, s[8:11], s37 offen lds
    buffer_load_dwordx4 v25, s[8:11], s37 offen offset:1024 lds
    s_add_u32 s76, s76, 8192
    s_cmp_ge_u32 s76, 155648
    s_cselect_b32 s76, s45, s76
    s_mov_b32 m0, s76
    s_add_u32 s37, s41, s57
    buffer_load_dwordx4 v24, s[8:11], s37 offen lds
    buffer_load_dwordx4 v25, s[8:11], s37 offen offset:1024 lds
    s_add_u32 s76, s76, 8192
    s_cmp_ge_u32 s76, 155648
    s_cselect_b32 s76, s45, s76
    s_mov_b32 s46, 0
    v_add_u32 v10, s77, v8
k_hl:
    s_waitcnt vmcnt(8) lgkmcnt(0)
    s_barrier
    ds_read_u16 v14, v10
    s_add_u32 m0, s55, 0
    s_add_u32 s37, s63, 0
    s_add_u32 s38, s63, 12800
    s_mov_b64 exec, s[52:53]
    buffer_load_dwordx4 v26, s[12:15], s37 offen lds
    buffer_load_dwordx4 v26, s[12:15], s38 offen offset:1024 lds
    s_mov_b64 exec, -1
    s_mov_b32 m0, s76
    s_add_u32 s37, s41, s58
    buffer_load_dwordx4 v24, s[8:11], s37 offen lds
    buffer_load_dwordx4 v25, s[8:11], s37 offen offset:1024 lds
    s_add_u32 s76, s76, 8192
    s_cmp_ge_u32 s76, 155648
    s_cselect_b32 s76, s45, s76
    s_mov_b32 m0, s76
    s_add_u32 s37, s41, s59
    buffer_load_dwordx4 v24, s[8:11], s37 offen lds
    buffer_load_dwordx4 v25, s[8:11], s37 offen offset:1024 lds
    s_add_u32 s76, s76, 8192
    s_cmp_ge_u32 s76, 155648
    s_cselect_b32 s76, s45, s76
    v_add_u32 v12, s55, v11
    s_add_u32 s77, s77, 128
    s_cmp_ge_u32 s77, 1152
    s_cselect_b32 s77, 0, s77
    v_add_u32 v10, s77, v8
    s_waitcnt vmcnt(8) lgkmcnt(0)
    s_barrier
    s_mov_b64 exec, 0xffff
    ds_write2_b32 v12, v14, v14 offset0:0 offset1:1
    s_add_u32 m0, s55, 2048
    s_add_u32 s37, s63, 27648
    s_add_u32 s38, s63, 40448
    s_mov_b64 exec, s[64:65]
    buffer_load_dwordx4 v27, s[12:15], s37 offen lds
    buffer_load_dwordx4 v27, s[12:15], s38 offen offset:1024 lds
    s_mov_b64 exec, -1
    s_add_u32 s43, s43, 128
    s_cmp_ge_u32 s43, 1152
    s_cselect_b32 s43, 0, s43
    s_add_u32 s41, s44, s43
    s_mov_b32 m0, s76
    s_add_u32 s37, s41, s56
    buffer_load_dwordx4 v24, s[8:11], s37 offen lds
    buffer_load_dwordx4 v25, s[8:11], s37 offen offset:1024 lds
    s_add_u32 s76, s76, 8192
    s_cmp_ge_u32 s76, 155648
    s_cselect_b32 s76, s45, s76
    s_mov_b32 m0, s76
    s_add_u32 s37, s41, s57
    buffer_load_dwordx4 v24, s[8:11], s37 offen lds
    buffer_load_dwordx4 v25, s[8:11], s37 offen offset:1024 lds
    s_add_u32 s76, s76, 8192
    s_cmp_ge_u32 s76, 155648
    s_cselect_b32 s76, s45, s76
    s_add_u32 s62, s62, 221184
    s_cmp_ge_u32 s62, 1990656
    s_cselect_b32 s62, 0, s62
    s_add_u32 s63, s54, s62
    s_add_u32 s55, s55, 16384
    s_sub_u32 s37, s55, 49152
    s_cmp_ge_u32 s55, 49152
    s_cselect_b32 s55, s37, s55
    s_add_u32 s46, s46, 1
    s_cmp_lt_u32 s46, 7
    s_cbranch_scc1 k_hl
    s_waitcnt vmcnt(8) lgkmcnt(0)
    s_barrier
    s_mov_b32 m0, s76
    s_add_u32 s37, s41, s58
    buffer_load_dwordx4 v24, s[8:11], s37 offen lds
    buffer_load_dwordx4 v25, s[8:11], s37 offen offset:1024 lds
    s_add_u32 s76, s76, 8192
    s_cmp_ge_u32 s76, 155648
    s_cselect_b32 s76, s45, s76
    s_mov_b32 m0, s76
    s_add_u32 s37, s41, s59
    buffer_load_dwordx4 v24, s[8:11], s37 offen lds
    buffer_load_dwordx4 v25, s[8:11], s37 offen offset:1024 lds
    s_add_u32 s76, s76, 8192
    s_cmp_ge_u32 s76, 155648
    s_cselect_b32 s76, s45, s76
    s_waitcnt vmcnt(6) lgkmcnt(0)
    s_barrier
    s_waitcnt vmcnt(2) lgkmcnt(0)
    s_barrier
    s_waitcnt vmcnt(0) lgkmcnt(0)
    s_barrier
    s_lshl_b32 s54, s33, 1
    s_and_b32 s37, s34, 1
    s_add_u32 s54, s54, s37
    s_lshr_b32 s55, s34, 1
    s_and_b32 s37, s54, 31
    s_mul_i32 s37, s37, 20736
    s_mul_i32 s38, s55, 288
    s_add_u32 s37, s37, s38
    s_mul_i32 s38, s32, 864
    s_add_u32 m0, s38, 151552
    s_mov_b32 exec_hi, 0x003fffff
    buffer_load_dwordx4 v28, s[16:19], s37 offen lds
    s_add_u32 m0, s38, 155008
    s_nop 0
    buffer_load_dwordx4 v29, s[16:19], s37 offen lds
    s_mov_b64 exec, 1
    buffer_load_dword v21, v17, s[24:27], 0 offen sc1
    s_mov_b64 exec, -1
    s_mul_i32 s45, s93, 75776
    s_mul_i32 s39, s94, 5120
    s_mul_i32 s38, s34, 18944
    s_add_u32 s38, s38, s47
    s_add_u32 s38, s38, s39
    s_mov_b32 s77, s94
    s_cmp_eq_u32 s94, 1
    s_cselect_b32 s52, 0xffff, -1
    s_cselect_b32 s53, 0, -1
    s_barrier
    ds_read_b128 v[32:35], v30 offset:0
    ds_read_b128 v[36:39], v30 offset:1024
    ds_read_b128 v[40:43], v30 offset:2048
    ds_read_b128 v[44:47], v30 offset:3072
    ds_read_b128 v[48:51], v30 offset:4096
    s_mov_b32 s44, s38
    s_waitcnt lgkmcnt(4)
    buffer_store_dwordx4 v[32:35], v7, s[28:31], s44 offen offset:0 sc1
    s_waitcnt lgkmcnt(3)
    buffer_store_dwordx4 v[36:39], v7, s[28:31], s44 offen offset:1024 sc1
    s_waitcnt lgkmcnt(2)
    buffer_store_dwordx4 v[40:43], v7, s[28:31], s44 offen offset:2048 sc1
    s_waitcnt lgkmcnt(1)
    buffer_store_dwordx4 v[44:47], v7, s[28:31], s44 offen offset:3072 sc1
    s_add_u32 s44, s44, 4096
    s_mov_b64 exec, s[52:53]
    s_waitcnt lgkmcnt(0)
    buffer_store_dwordx4 v[48:51], v7, s[28:31], s44 offen offset:0 sc1
    s_mov_b64 exec, -1
    s_add_u32 s44, s44, 5376
    s_barrier
    ds_read_b128 v[52:55], v30 offset:9472
    ds_read_b128 v[56:59], v30 offset:10496
    ds_read_b128 v[60:63], v30 offset:11520
    ds_read_b128 v[64:67], v30 offset:12544
    ds_read_b128 v[68:71], v30 offset:13568
    s_lshl_b32 s37, s34, 8
    s_lshl_b32 s38, s94, 2
    s_add_u32 s37, s37, s38
    s_mov_b64 exec, 1
    s_waitcnt vmcnt(0)
    buffer_store_dword v19, v16, s[28:31], s37 offen offset:0 sc1
    s_mov_b64 exec, -1
    s_mov_b64 exec, 1
    v_readfirstlane_b32 s37, v21
    s_and_b32 s37, s37, 0xff
    s_cmp_ge_u32 s37, 8
    s_cbranch_scc1 k_pl0_go
    s_mov_b32 s48, 40000
k_pl0:
    buffer_load_dword v20, v17, s[24:27], 0 offen sc1
    s_waitcnt vmcnt(0)
    v_readfirstlane_b32 s37, v20
    s_and_b32 s37, s37, 0xff
    s_cmp_ge_u32 s37, 8
    s_cbranch_scc1 k_pl0_go
    s_sub_u32 s48, s48, 1
    s_cmp_eq_u32 s48, 0
    s_cbranch_scc1 k_pl0_go
    s_sleep 8
    s_branch k_pl0
k_pl0_go:
    s_add_u32 s39, s94, 1
    s_xor_b32 s39, s39, s34
    s_lshl_b32 s39, s39, 8
    s_mov_b64 exec, 3
    s_mov_b32 s48, 40000
k_pl1:
    buffer_load_dword v20, v16, s[28:31], s39 offen sc1
    s_waitcnt vmcnt(0)
    v_cmp_eq_u32 vcc, 1, v20
    s_nop 1
    s_cmp_eq_u32 vcc_lo, 3
    s_cbranch_scc1 k_pl1_go
    s_sub_u32 s48, s48, 1
    s_cmp_eq_u32 s48, 0
    s_cbranch_scc1 k_pl1_go
    s_sleep 1
    s_branch k_pl1
k_pl1_go:
    s_mov_b64 exec, -1
    s_call_b64 s[50:51], k_ldblk
    s_waitcnt lgkmcnt(0)
    buffer_store_dwordx4 v[52:55], v7, s[28:31], s44 offen offset:0 sc1
    buffer_store_dwordx4 v[56:59], v7, s[28:31], s44 offen offset:1024 sc1
    buffer_store_dwordx4 v[60:63], v7, s[28:31], s44 offen offset:2048 sc1
    buffer_store_dwordx4 v[64:67], v7, s[28:31], s44 offen offset:3072 sc1
    s_add_u32 s44, s44, 4096
    s_mov_b64 exec, s[52:53]
    buffer_store_dwordx4 v[68:71], v7, s[28:31], s44 offen offset:0 sc1
    s_mov_b64 exec, -1
    s_add_u32 s44, s44, 5376
    s_waitcnt vmcnt(5)
    s_barrier
    s_lshl_b32 s37, s34, 8
    s_lshl_b32 s38, s94, 2
    s_add_u32 s37, s37, s38
    s_mov_b64 exec, 1
    s_waitcnt vmcnt(0)
    buffer_store_dword v19, v16, s[28:31], s37 offen offset:2048 sc1
    s_mov_b64 exec, -1
    s_mov_b64 exec, 0xffff
    s_mov_b32 s48, 40000
k_pl1a:
    buffer_load_dword v20, v16, s[28:31], 0 offen sc1
    s_waitcnt vmcnt(0)
    v_cmp_eq_u32 vcc, 1, v20
    s_nop 1
    s_cmp_eq_u32 vcc_lo, 0xffff
    s_cbranch_scc1 k_pl1a_go
    s_sub_u32 s48, s48, 1
    s_cmp_eq_u32 s48, 0
    s_cbranch_scc1 k_pl1a_go
    s_sleep 2
    s_branch k_pl1a
k_pl1a_go:
    s_mov_b64 exec, -1
    s_call_b64 s[50:51], k_ldblk
    s_call_b64 s[50:51], k_ldblk
    s_waitcnt vmcnt(0)
    s_barrier
    s_mov_b64 exec, 0xffff
    s_mov_b32 s48, 40000
k_pl1b:
    buffer_load_dword v20, v16, s[28:31], 0 offen offset:2048 sc1
    s_waitcnt vmcnt(0)
    v_cmp_eq_u32 vcc, 1, v20
    s_nop 1
    s_cmp_eq_u32 vcc_lo, 0xffff
    s_cbranch_scc1 k_pl1b_go
    s_sub_u32 s48, s48, 1
    s_cmp_eq_u32 s48, 0
    s_cbranch_scc1 k_pl1b_go
    s_sleep 2
    s_branch k_pl1b
k_pl1b_go:
    s_mov_b64 exec, -1
    s_call_b64 s[50:51], k_ldblk
    s_call_b64 s[50:51], k_ldblk
    ds_read_b64_tr_b16 v[64:65], v76
    ds_read_b64_tr_b16 v[66:67], v76 offset:2304
    ds_read_b64_tr_b16 v[68:69], v77 offset:256
    ds_read_b64_tr_b16 v[70:71], v77 offset:2560
    ds_read_b64_tr_b16 v[72:73], v78 offset:4480
    s_lshl_b32 s37, s55, 6
    s_add_u32 s37, s37, s54
    s_mul_i32 s37, s37, 4608
    s_add_u32 s37, s37, 15728640
    s_lshl_b32 s38, s32, 10
    s_add_u32 s38, s38, s37
    s_lshl_b32 s39, s55, 4
    s_lshr_b32 s40, s54, 2
    s_add_u32 s39, s39, s40
    s_mul_i32 s39, s39, 2304
    s_and_b32 s40, s54, 3
    s_lshl_b32 s40, s40, 2
    s_add_u32 s39, s39, s40
    s_lshl_b32 s40, s32, 10
    s_add_u32 s39, s39, s40
    s_add_u32 s39, s39, 17300480
    s_waitcnt lgkmcnt(0)
    buffer_store_dwordx4 v[64:67], v7, s[28:31], s38 offen sc1
    s_cmp_eq_u32 s32, 0
    s_cbranch_scc0 k_wo_tail
    s_mov_b32 exec_hi, 0
    s_add_u32 s40, s37, 4096
    buffer_store_dwordx4 v[68:71], v7, s[28:31], s40 offen sc1
    s_branch k_wo_done
k_wo_tail:
    s_cmp_eq_u32 s32, 3
    s_cselect_b32 exec_lo, 0xffff, -1
    s_cselect_b32 exec_hi, 0, -1
    buffer_store_dword v72, v7, s[28:31], s39 offen sc1
k_wo_done:
    s_mov_b64 exec, -1
    s_lshl_b32 s38, s34, 1
    s_add_u32 s38, s38, s94
    s_lshl_b32 s38, s38, 9
    s_add_u32 s38, s38, s79
    s_mul_i32 s38, s38, 576
    s_and_b32 s37, s79, 7
    s_lshl_b32 s37, s37, 6
    s_sub_u32 s38, s38, s37
    s_add_u32 s38, s38, 10485760
    s_mov_b32 exec_hi, 15
    buffer_store_dwordx4 v[80:83], v88, s[28:31], s38 offen sc1
    s_add_u32 s38, s38, 36864
    buffer_store_dwordx4 v[80:83], v88, s[28:31], s38 offen sc1
    s_add_u32 s38, s38, 36864
    buffer_store_dwordx4 v[80:83], v88, s[28:31], s38 offen sc1
    s_add_u32 s38, s38, 36864
    buffer_store_dwordx4 v[80:83], v88, s[28:31], s38 offen sc1
    s_add_u32 s38, s38, 36864
    buffer_store_dwordx4 v[80:83], v88, s[28:31], s38 offen sc1
    s_add_u32 s38, s38, 36864
    buffer_store_dwordx4 v[80:83], v88, s[28:31], s38 offen sc1
    s_add_u32 s38, s38, 36864
    buffer_store_dwordx4 v[80:83], v88, s[28:31], s38 offen sc1
    s_add_u32 s38, s38, 36864
    buffer_store_dwordx4 v[80:83], v88, s[28:31], s38 offen sc1
    s_add_u32 s38, s38, 36864
    s_mov_b64 exec, 1
    s_waitcnt vmcnt(0)
    ds_add_rtn_u32 v20, v18, v19 offset:4
    s_waitcnt lgkmcnt(0)
    v_readfirstlane_b32 s38, v20
    s_mov_b64 exec, -1
    s_cmp_eq_u32 s38, 3
    s_cbranch_scc0 k_sg2
    s_mov_b64 exec, 1
    buffer_atomic_add v31, v17, s[24:27], 0 offen
    s_mov_b64 exec, -1
k_sg2:
    s_barrier
    s_call_b64 s[50:51], k_ldblk
    s_call_b64 s[50:51], k_ldblk
    s_cmp_eq_u32 s32, 0
    s_cbranch_scc0 k_gw
    s_mov_b32 exec_hi, 0
    s_mov_b32 s48, 40000
k_pl2:
    buffer_load_dword v20, v79, s[24:27], 0 offen sc1
    s_waitcnt vmcnt(0)
    v_bfe_u32 v20, v20, 8, 8
    v_cmp_le_u32 vcc, 8, v20
    s_nop 1
    s_cmp_eq_u32 vcc_lo, -1
    s_cbranch_scc1 k_pl2_go
    s_sub_u32 s48, s48, 1
    s_cmp_eq_u32 s48, 0
    s_cbranch_scc1 k_pl2_go
    s_sleep 32
    s_branch k_pl2
k_pl2_go:
    ds_write_b32 v18, v19 offset:12
    s_mov_b64 exec, -1
    s_branch k_ggo
k_gw:
    s_mov_b32 s48, 400000
k_lw2:
    ds_read_b32 v20, v18 offset:12
    s_waitcnt lgkmcnt(0)
    v_readfirstlane_b32 s38, v20
    s_cmp_lg_u32 s38, 0
    s_cbranch_scc1 k_lw2_go
    s_sub_u32 s48, s48, 1
    s_cmp_eq_u32 s48, 0
    s_cbranch_scc1 k_lw2_go
    s_sleep 6
    s_branch k_lw2
k_lw2_go:
k_ggo:
    s_add_u32 s40, s70, 0
    buffer_load_dwordx4 v[8:11], v4, s[28:31], s40 offen offset:0 sc1
    buffer_load_dwordx4 v[12:15], v4, s[28:31], s40 offen offset:512 sc1
    buffer_load_dwordx4 v[16:19], v4, s[28:31], s40 offen offset:1024 sc1
    buffer_load_dwordx4 v[20:23], v4, s[28:31], s40 offen offset:1536 sc1
    buffer_load_dwordx4 v[24:27], v4, s[28:31], s40 offen offset:2048 sc1
    s_add_u32 s40, s70, 9216
    buffer_load_dwordx4 v[28:31], v4, s[28:31], s40 offen offset:0 sc1
    buffer_load_dwordx4 v[32:35], v4, s[28:31], s40 offen offset:512 sc1
    buffer_load_dwordx4 v[36:39], v4, s[28:31], s40 offen offset:1024 sc1
    buffer_load_dwordx4 v[40:43], v4, s[28:31], s40 offen offset:1536 sc1
    buffer_load_dwordx4 v[44:47], v4, s[28:31], s40 offen offset:2048 sc1
    s_add_u32 s40, s70, 18432
    buffer_load_dwordx4 v[48:51], v4, s[28:31], s40 offen offset:0 sc1
    buffer_load_dwordx4 v[52:55], v4, s[28:31], s40 offen offset:512 sc1
    buffer_load_dwordx4 v[56:59], v4, s[28:31], s40 offen offset:1024 sc1
    buffer_load_dwordx4 v[60:63], v4, s[28:31], s40 offen offset:1536 sc1
    buffer_load_dwordx4 v[64:67], v4, s[28:31], s40 offen offset:2048 sc1
    s_add_u32 s40, s70, 27648
    buffer_load_dwordx4 v[68:71], v4, s[28:31], s40 offen offset:0 sc1
    buffer_load_dwordx4 v[72:75], v4, s[28:31], s40 offen offset:512 sc1
    buffer_load_dwordx4 v[76:79], v4, s[28:31], s40 offen offset:1024 sc1
    buffer_load_dwordx4 v[80:83], v4, s[28:31], s40 offen offset:1536 sc1
    buffer_load_dwordx4 v[84:87], v4, s[28:31], s40 offen offset:2048 sc1
    s_add_u32 s40, s71, 0
    buffer_load_dwordx4 v[88:91], v4, s[28:31], s40 offen offset:0 sc1
    buffer_load_dwordx4 v[92:95], v4, s[28:31], s40 offen offset:512 sc1
    buffer_load_dwordx4 v[96:99], v4, s[28:31], s40 offen offset:1024 sc1
    buffer_load_dwordx4 v[100:103], v4, s[28:31], s40 offen offset:1536 sc1
    buffer_load_dwordx4 v[104:107], v4, s[28:31], s40 offen offset:2048 sc1
    s_add_u32 s40, s71, 9216
    buffer_load_dwordx4 v[108:111], v4, s[28:31], s40 offen offset:0 sc1
    buffer_load_dwordx4 v[112:115], v4, s[28:31], s40 offen offset:512 sc1
    buffer_load_dwordx4 v[116:119], v4, s[28:31], s40 offen offset:1024 sc1
    buffer_load_dwordx4 v[120:123], v4, s[28:31], s40 offen offset:1536 sc1
    buffer_load_dwordx4 v[124:127], v4, s[28:31], s40 offen offset:2048 sc1
    s_add_u32 s40, s71, 18432
    buffer_load_dwordx4 v[128:131], v4, s[28:31], s40 offen offset:0 sc1
    buffer_load_dwordx4 v[132:135], v4, s[28:31], s40 offen offset:512 sc1
    buffer_load_dwordx4 v[136:139], v4, s[28:31], s40 offen offset:1024 sc1
    buffer_load_dwordx4 v[140:143], v4, s[28:31], s40 offen offset:1536 sc1
    buffer_load_dwordx4 v[144:147], v4, s[28:31], s40 offen offset:2048 sc1
    s_add_u32 s40, s71, 27648
    buffer_load_dwordx4 v[148:151], v4, s[28:31], s40 offen offset:0 sc1
    buffer_load_dwordx4 v[152:155], v4, s[28:31], s40 offen offset:512 sc1
    buffer_load_dwordx4 v[156:159], v4, s[28:31], s40 offen offset:1024 sc1
    buffer_load_dwordx4 v[160:163], v4, s[28:31], s40 offen offset:1536 sc1
    buffer_load_dwordx4 v[164:167], v4, s[28:31], s40 offen offset:2048 sc1
    buffer_load_dwordx4 v[168:171], v5, s[28:31], s92 offen offset:0 sc1
    buffer_load_dwordx4 v[172:175], v5, s[28:31], s92 offen offset:256 sc1
    buffer_load_dwordx4 v[176:179], v5, s[28:31], s92 offen offset:512 sc1
    buffer_load_dwordx4 v[180:183], v5, s[28:31], s92 offen offset:768 sc1
    buffer_load_dwordx4 v[184:187], v5, s[28:31], s92 offen offset:1024 sc1
    s_waitcnt vmcnt(45)
    s_barrier
    s_add_u32 s40, s70, 4096
    buffer_load_dwordx4 v[228:231], v4, s[28:31], s40 offen offset:0 sc1
    s_add_u32 s40, s70, 13312
    buffer_load_dwordx4 v[232:235], v4, s[28:31], s40 offen offset:0 sc1
    s_add_u32 s40, s70, 22528
    buffer_load_dwordx4 v[236:239], v4, s[28:31], s40 offen offset:0 sc1
    s_add_u32 s40, s70, 31744
    buffer_load_dwordx4 v[240:243], v4, s[28:31], s40 offen offset:0 sc1
    s_add_u32 s40, s71, 4096
    buffer_load_dwordx4 v[228:231], v4, s[28:31], s40 offen offset:0 sc1
    s_add_u32 s40, s71, 13312
    buffer_load_dwordx4 v[232:235], v4, s[28:31], s40 offen offset:0 sc1
    s_add_u32 s40, s71, 22528
    buffer_load_dwordx4 v[236:239], v4, s[28:31], s40 offen offset:0 sc1
    s_add_u32 s40, s71, 31744
    buffer_load_dwordx4 v[240:243], v4, s[28:31], s40 offen offset:0 sc1
    buffer_load_dwordx4 v[228:231], v5, s[28:31], s92 offen offset:2048 sc1
    s_mul_i32 s37, s94, 27648
    s_add_u32 s37, s37, s45
    s_barrier
    s_add_u32 m0, s37, 0
    s_add_u32 s40, s70, 2560
    buffer_load_dwordx4 v4, s[28:31], s40 offen sc1 lds
    s_add_u32 m0, s37, 1024
    s_add_u32 s40, s70, 3072
    buffer_load_dwordx4 v4, s[28:31], s40 offen sc1 lds
    s_add_u32 m0, s37, 2048
    s_add_u32 s40, s70, 3584
    buffer_load_dwordx4 v4, s[28:31], s40 offen sc1 lds
    s_add_u32 m0, s37, 3072
    s_add_u32 s40, s70, 11776
    buffer_load_dwordx4 v4, s[28:31], s40 offen sc1 lds
    s_add_u32 m0, s37, 4096
    s_add_u32 s40, s70, 12288
    buffer_load_dwordx4 v4, s[28:31], s40 offen sc1 lds
    s_add_u32 m0, s37, 5120
    s_add_u32 s40, s70, 12800
    buffer_load_dwordx4 v4, s[28:31], s40 offen sc1 lds
    s_add_u32 m0, s37, 6144
    s_add_u32 s40, s70, 20992
    buffer_load_dwordx4 v4, s[28:31], s40 offen sc1 lds
    s_add_u32 m0, s37, 7168
    s_add_u32 s40, s70, 21504
    buffer_load_dwordx4 v4, s[28:31], s40 offen sc1 lds
    s_add_u32 m0, s37, 8192
    s_add_u32 s40, s70, 22016
    buffer_load_dwordx4 v4, s[28:31], s40 offen sc1 lds
    s_add_u32 m0, s37, 9216
    s_add_u32 s40, s70, 30208
    buffer_load_dwordx4 v4, s[28:31], s40 offen sc1 lds
    s_add_u32 m0, s37, 10240
    s_add_u32 s40, s70, 30720
    buffer_load_dwordx4 v4, s[28:31], s40 offen sc1 lds
    s_add_u32 m0, s37, 11264
    s_add_u32 s40, s70, 31232
    buffer_load_dwordx4 v4, s[28:31], s40 offen sc1 lds
    s_add_u32 m0, s37, 12288
    s_add_u32 s40, s71, 2560
    buffer_load_dwordx4 v4, s[28:31], s40 offen sc1 lds
    s_add_u32 m0, s37, 13312
    s_add_u32 s40, s71, 3072
    buffer_load_dwordx4 v4, s[28:31], s40 offen sc1 lds
    s_add_u32 m0, s37, 14336
    s_add_u32 s40, s71, 3584
    buffer_load_dwordx4 v4, s[28:31], s40 offen sc1 lds
    s_add_u32 m0, s37, 15360
    s_add_u32 s40, s71, 11776
    buffer_load_dwordx4 v4, s[28:31], s40 offen sc1 lds
    s_add_u32 m0, s37, 16384
    s_add_u32 s40, s71, 12288
    buffer_load_dwordx4 v4, s[28:31], s40 offen sc1 lds
    s_add_u32 m0, s37, 17408
    s_add_u32 s40, s71, 12800
    buffer_load_dwordx4 v4, s[28:31], s40 offen sc1 lds
    s_add_u32 m0, s37, 18432
    s_add_u32 s40, s71, 20992
    buffer_load_dwordx4 v4, s[28:31], s40 offen sc1 lds
    s_add_u32 m0, s37, 19456
    s_add_u32 s40, s71, 21504
    buffer_load_dwordx4 v4, s[28:31], s40 offen sc1 lds
    s_add_u32 m0, s37, 20480
    s_add_u32 s40, s71, 22016
    buffer_load_dwordx4 v4, s[28:31], s40 offen sc1 lds
    s_add_u32 m0, s37, 21504
    s_add_u32 s40, s71, 30208
    buffer_load_dwordx4 v4, s[28:31], s40 offen sc1 lds
    s_add_u32 m0, s37, 22528
    s_add_u32 s40, s71, 30720
    buffer_load_dwordx4 v4, s[28:31], s40 offen sc1 lds
    s_add_u32 m0, s37, 23552
    s_add_u32 s40, s71, 31232
    buffer_load_dwordx4 v4, s[28:31], s40 offen sc1 lds
    s_add_u32 m0, s37, 24576
    s_add_u32 s40, s92, 1280
    buffer_load_dwordx4 v5, s[28:31], s40 offen sc1 lds
    s_add_u32 m0, s37, 25600
    s_add_u32 s40, s92, 1536
    buffer_load_dwordx4 v5, s[28:31], s40 offen sc1 lds
    s_add_u32 m0, s37, 26624
    s_add_u32 s40, s92, 1792
    buffer_load_dwordx4 v5, s[28:31], s40 offen sc1 lds
    s_waitcnt vmcnt(0)
    s_setprio 3
    s_barrier
    s_mov_b32 s48, 60000
    s_mov_b32 s46, 4294967295
    s_mov_b32 s42, 0
    s_mov_b32 s62, 0
    s_mov_b32 s63, 0
    s_mov_b32 s44, 12
    s_mov_b32 s62, 3
    s_add_u32 m0, s74, 0
    s_add_u32 s40, s66, 4096
    buffer_load_dwordx4 v7, s[28:31], s66 offen offset:0 sc1 lds
    buffer_load_dwordx4 v7, s[28:31], s66 offen offset:1024 sc1 lds
    buffer_load_dwordx4 v7, s[28:31], s66 offen offset:2048 sc1 lds
    buffer_load_dwordx4 v7, s[28:31], s66 offen offset:3072 sc1 lds
    s_add_u32 m0, s74, 4096
    s_mov_b32 exec_hi, 0
    buffer_load_dwordx4 v7, s[28:31], s40 offen sc1 lds
    s_mov_b64 exec, -1
    s_add_u32 m0, s74, 4608
    s_add_u32 s40, s67, 4096
    buffer_load_dwordx4 v7, s[28:31], s67 offen offset:0 sc1 lds
    buffer_load_dwordx4 v7, s[28:31], s67 offen offset:1024 sc1 lds
    buffer_load_dwordx4 v7, s[28:31], s67 offen offset:2048 sc1 lds
    buffer_load_dwordx4 v7, s[28:31], s67 offen offset:3072 sc1 lds
    s_add_u32 m0, s74, 8704
    s_mov_b32 exec_hi, 0
    buffer_load_dwordx4 v7, s[28:31], s40 offen sc1 lds
    s_mov_b64 exec, -1
h3_round:
    s_or_b32 s37, s42, s62
    s_andn2_b32 s37, 15, s37
    s_cbranch_scc1 h3_hint
    s_waitcnt vmcnt(0)
    s_branch h3_nohint
h3_hint:
    s_mul_i32 s37, s37, 0x00204081
    s_and_b32 s37, s37, 0x01010101
    s_mul_i32 exec_lo, s37, 0xff
    s_mov_b32 exec_hi, 0
    buffer_load_dword v246, v249, s[28:31], s90 offen sc1
    s_mov_b64 exec, -1
h3_nohint:
    s_cmp_eq_u32 s62, 0
    s_cbranch_scc1 h3_nofly
    s_or_b32 s63, s63, s62
    s_waitcnt vmcnt(1)
    v_mov_b32 v247, s63
    ds_write_b32 v251, v247
h3_nofly:
    s_mov_b32 s43, s62
    s_or_b32 s38, s42, s43
    s_cmp_eq_u32 s38, 15
    s_mov_b32 s62, 0
    s_cbranch_scc1 h3_work
    s_waitcnt vmcnt(0)
    ds_read_b32 v1, v250
    v_cmp_ne_u32 vcc, s46, v246
    s_waitcnt lgkmcnt(0)
    v_readfirstlane_b32 s37, v1
    s_cmp_ge_u32 s37, 4
    s_cselect_b32 s44, 0, s44
    s_or_b32 s38, s38, s44
h3_spec:
    s_bitcmp1_b32 s38, 0
    s_cbranch_scc1 h3_l0
    s_bfe_u32 s37, vcc_lo, 524288
    s_cmp_eq_u32 s37, 0xff
    s_cbranch_scc0 h3_l0
    s_bitset1_b32 s62, 0
    s_add_u32 m0, s74, 0
    s_add_u32 s40, s66, 4096
    buffer_load_dwordx4 v7, s[28:31], s66 offen offset:0 sc1 lds
    buffer_load_dwordx4 v7, s[28:31], s66 offen offset:1024 sc1 lds
    buffer_load_dwordx4 v7, s[28:31], s66 offen offset:2048 sc1 lds
    buffer_load_dwordx4 v7, s[28:31], s66 offen offset:3072 sc1 lds
    s_add_u32 m0, s74, 4096
    s_mov_b32 exec_hi, 0
    buffer_load_dwordx4 v7, s[28:31], s40 offen sc1 lds
    s_mov_b64 exec, -1
h3_l0:
    s_bitcmp1_b32 s38, 1
    s_cbranch_scc1 h3_l1
    s_bfe_u32 s37, vcc_lo, 524296
    s_cmp_eq_u32 s37, 0xff
    s_cbranch_scc0 h3_l1
    s_bitset1_b32 s62, 1
    s_add_u32 m0, s74, 4608
    s_add_u32 s40, s67, 4096
    buffer_load_dwordx4 v7, s[28:31], s67 offen offset:0 sc1 lds
    buffer_load_dwordx4 v7, s[28:31], s67 offen offset:1024 sc1 lds
    buffer_load_dwordx4 v7, s[28:31], s67 offen offset:2048 sc1 lds
    buffer_load_dwordx4 v7, s[28:31], s67 offen offset:3072 sc1 lds
    s_add_u32 m0, s74, 8704
    s_mov_b32 exec_hi, 0
    buffer_load_dwordx4 v7, s[28:31], s40 offen sc1 lds
    s_mov_b64 exec, -1
h3_l1:
    s_bitcmp1_b32 s38, 2
    s_cbranch_scc1 h3_l2
    s_bfe_u32 s37, vcc_lo, 524304
    s_cmp_eq_u32 s37, 0xff
    s_cbranch_scc0 h3_l2
    s_bitset1_b32 s62, 2
    s_add_u32 m0, s75, 0
    s_add_u32 s40, s68, 4096
    buffer_load_dwordx4 v7, s[28:31], s68 offen offset:0 sc1 lds
    buffer_load_dwordx4 v7, s[28:31], s68 offen offset:1024 sc1 lds
    buffer_load_dwordx4 v7, s[28:31], s68 offen offset:2048 sc1 lds
    buffer_load_dwordx4 v7, s[28:31], s68 offen offset:3072 sc1 lds
    s_add_u32 m0, s75, 4096
    s_mov_b32 exec_hi, 0
    buffer_load_dwordx4 v7, s[28:31], s40 offen sc1 lds
    s_mov_b64 exec, -1
h3_l2:
    s_bitcmp1_b32 s38, 3
    s_cbranch_scc1 h3_l3
    s_bfe_u32 s37, vcc_lo, 524312
    s_cmp_eq_u32 s37, 0xff
    s_cbranch_scc0 h3_l3
    s_bitset1_b32 s62, 3
    s_add_u32 m0, s75, 4608
    s_add_u32 s40, s69, 4096
    buffer_load_dwordx4 v7, s[28:31], s69 offen offset:0 sc1 lds
    buffer_load_dwordx4 v7, s[28:31], s69 offen offset:1024 sc1 lds
    buffer_load_dwordx4 v7, s[28:31], s69 offen offset:2048 sc1 lds
    buffer_load_dwordx4 v7, s[28:31], s69 offen offset:3072 sc1 lds
    s_add_u32 m0, s75, 8704
    s_mov_b32 exec_hi, 0
    buffer_load_dwordx4 v7, s[28:31], s40 offen sc1 lds
    s_mov_b64 exec, -1
h3_l3:
h3_work:
    s_bitcmp1_b32 s43, 0
    s_cbranch_scc0 h3_n0
    ds_read_b128 v[228:231], v2 offset:0
    ds_read_b128 v[232:235], v2 offset:1024
    ds_read_b128 v[236:239], v2 offset:2048
    ds_read_b128 v[240:243], v2 offset:3072
    ds_read_b64 v[244:245], v248 offset:0
    s_waitcnt lgkmcnt(3)
    v_max3_u32 v1, v228, v229, v230
    v_max3_u32 v1, v231, v232, v1
    v_max3_u32 v1, v233, v234, v1
    s_waitcnt lgkmcnt(0)
    v_max3_u32 v1, v235, v236, v1
    v_max3_u32 v1, v237, v238, v1
    v_max3_u32 v1, v239, v240, v1
    v_max3_u32 v1, v241, v242, v1
    v_max3_u32 v1, v243, v244, v1
    v_max_u32 v1, v245, v1
    v_cmp_eq_u32 vcc, s46, v1
    s_nop 1
    s_cbranch_vccnz h3_n0
    s_bitset1_b32 s42, 0
    v_mfma_f32_16x16x32_bf16 v[188:191], v[8:11], v[228:231], v[188:191]
    v_mfma_f32_16x16x32_bf16 v[196:199], v[12:15], v[228:231], v[196:199]
    v_mfma_f32_16x16x32_bf16 v[204:207], v[16:19], v[228:231], v[204:207]
    v_mfma_f32_16x16x32_bf16 v[212:215], v[20:23], v[228:231], v[212:215]
    v_mfma_f32_16x16x32_bf16 v[220:223], v[24:27], v[228:231], v[220:223]
    v_mfma_f32_16x16x32_bf16 v[188:191], v[28:31], v[232:235], v[188:191]
    v_mfma_f32_16x16x32_bf16 v[196:199], v[32:35], v[232:235], v[196:199]
    v_mfma_f32_16x16x32_bf16 v[204:207], v[36:39], v[232:235], v[204:207]
    v_mfma_f32_16x16x32_bf16 v[212:215], v[40:43], v[232:235], v[212:215]
    v_mfma_f32_16x16x32_bf16 v[220:223], v[44:47], v[232:235], v[220:223]
    v_mfma_f32_16x16x32_bf16 v[188:191], v[48:51], v[236:239], v[188:191]
    v_mfma_f32_16x16x32_bf16 v[196:199], v[52:55], v[236:239], v[196:199]
    v_mfma_f32_16x16x32_bf16 v[204:207], v[56:59], v[236:239], v[204:207]
    v_mfma_f32_16x16x32_bf16 v[212:215], v[60:63], v[236:239], v[212:215]
    v_mfma_f32_16x16x32_bf16 v[220:223], v[64:67], v[236:239], v[220:223]
    v_mfma_f32_16x16x32_bf16 v[188:191], v[68:71], v[240:243], v[188:191]
    v_mfma_f32_16x16x32_bf16 v[196:199], v[72:75], v[240:243], v[196:199]
    v_mfma_f32_16x16x32_bf16 v[204:207], v[76:79], v[240:243], v[204:207]
    v_mfma_f32_16x16x32_bf16 v[212:215], v[80:83], v[240:243], v[212:215]
    v_mfma_f32_16x16x32_bf16 v[220:223], v[84:87], v[240:243], v[220:223]
h3_n0:
    s_bitcmp1_b32 s43, 1
    s_cbranch_scc0 h3_n1
    ds_read_b128 v[228:231], v2 offset:4608
    ds_read_b128 v[232:235], v2 offset:5632
    ds_read_b128 v[236:239], v2 offset:6656
    ds_read_b128 v[240:243], v2 offset:7680
    ds_read_b64 v[244:245], v248 offset:4608
    s_waitcnt lgkmcnt(3)
    v_max3_u32 v1, v228, v229, v230
    v_max3_u32 v1, v231, v232, v1
    v_max3_u32 v1, v233, v234, v1
    s_waitcnt lgkmcnt(0)
    v_max3_u32 v1, v235, v236, v1
    v_max3_u32 v1, v237, v238, v1
    v_max3_u32 v1, v239, v240, v1
    v_max3_u32 v1, v241, v242, v1
    v_max3_u32 v1, v243, v244, v1
    v_max_u32 v1, v245, v1
    v_cmp_eq_u32 vcc, s46, v1
    s_nop 1
    s_cbranch_vccnz h3_n1
    s_bitset1_b32 s42, 1
    v_mfma_f32_16x16x32_bf16 v[188:191], v[88:91], v[228:231], v[188:191]
    v_mfma_f32_16x16x32_bf16 v[196:199], v[92:95], v[228:231], v[196:199]
    v_mfma_f32_16x16x32_bf16 v[204:207], v[96:99], v[228:231], v[204:207]
    v_mfma_f32_16x16x32_bf16 v[212:215], v[100:103], v[228:231], v[212:215]
    v_mfma_f32_16x16x32_bf16 v[220:223], v[104:107], v[228:231], v[220:223]
    v_mfma_f32_16x16x32_bf16 v[188:191], v[108:111], v[232:235], v[188:191]
    v_mfma_f32_16x16x32_bf16 v[196:199], v[112:115], v[232:235], v[196:199]
    v_mfma_f32_16x16x32_bf16 v[204:207], v[116:119], v[232:235], v[204:207]
    v_mfma_f32_16x16x32_bf16 v[212:215], v[120:123], v[232:235], v[212:215]
    v_mfma_f32_16x16x32_bf16 v[220:223], v[124:127], v[232:235], v[220:223]
    v_mfma_f32_16x16x32_bf16 v[188:191], v[128:131], v[236:239], v[188:191]
    v_mfma_f32_16x16x32_bf16 v[196:199], v[132:135], v[236:239], v[196:199]
    v_mfma_f32_16x16x32_bf16 v[204:207], v[136:139], v[236:239], v[204:207]
    v_mfma_f32_16x16x32_bf16 v[212:215], v[140:143], v[236:239], v[212:215]
    v_mfma_f32_16x16x32_bf16 v[220:223], v[144:147], v[236:239], v[220:223]
    v_mfma_f32_16x16x32_bf16 v[188:191], v[148:151], v[240:243], v[188:191]
    v_mfma_f32_16x16x32_bf16 v[196:199], v[152:155], v[240:243], v[196:199]
    v_mfma_f32_16x16x32_bf16 v[204:207], v[156:159], v[240:243], v[204:207]
    v_mfma_f32_16x16x32_bf16 v[212:215], v[160:163], v[240:243], v[212:215]
    v_mfma_f32_16x16x32_bf16 v[220:223], v[164:167], v[240:243], v[220:223]
h3_n1:
    s_bitcmp1_b32 s43, 2
    s_cbranch_scc0 h3_n2
    ds_read_b128 v[228:231], v252 offset:0
    ds_read_b128 v[232:235], v252 offset:1024
    ds_read_b128 v[236:239], v252 offset:2048
    ds_read_b128 v[240:243], v252 offset:3072
    ds_read_b64 v[244:245], v253 offset:0
    s_waitcnt lgkmcnt(3)
    v_max3_u32 v1, v228, v229, v230
    v_max3_u32 v1, v231, v232, v1
    v_max3_u32 v1, v233, v234, v1
    s_waitcnt lgkmcnt(0)
    v_max3_u32 v1, v235, v236, v1
    v_max3_u32 v1, v237, v238, v1
    v_max3_u32 v1, v239, v240, v1
    v_max3_u32 v1, v241, v242, v1
    v_max3_u32 v1, v243, v244, v1
    v_max_u32 v1, v245, v1
    v_cmp_eq_u32 vcc, s46, v1
    s_nop 1
    s_cbranch_vccnz h3_n2
    s_bitset1_b32 s42, 2
    v_mfma_f32_16x16x32_bf16 v[192:195], v[8:11], v[228:231], v[192:195]
    v_mfma_f32_16x16x32_bf16 v[200:203], v[12:15], v[228:231], v[200:203]
    v_mfma_f32_16x16x32_bf16 v[208:211], v[16:19], v[228:231], v[208:211]
    v_mfma_f32_16x16x32_bf16 v[216:219], v[20:23], v[228:231], v[216:219]
    v_mfma_f32_16x16x32_bf16 v[224:227], v[24:27], v[228:231], v[224:227]
    v_mfma_f32_16x16x32_bf16 v[192:195], v[28:31], v[232:235], v[192:195]
    v_mfma_f32_16x16x32_bf16 v[200:203], v[32:35], v[232:235], v[200:203]
    v_mfma_f32_16x16x32_bf16 v[208:211], v[36:39], v[232:235], v[208:211]
    v_mfma_f32_16x16x32_bf16 v[216:219], v[40:43], v[232:235], v[216:219]
    v_mfma_f32_16x16x32_bf16 v[224:227], v[44:47], v[232:235], v[224:227]
    v_mfma_f32_16x16x32_bf16 v[192:195], v[48:51], v[236:239], v[192:195]
    v_mfma_f32_16x16x32_bf16 v[200:203], v[52:55], v[236:239], v[200:203]
    v_mfma_f32_16x16x32_bf16 v[208:211], v[56:59], v[236:239], v[208:211]
    v_mfma_f32_16x16x32_bf16 v[216:219], v[60:63], v[236:239], v[216:219]
    v_mfma_f32_16x16x32_bf16 v[224:227], v[64:67], v[236:239], v[224:227]
    v_mfma_f32_16x16x32_bf16 v[192:195], v[68:71], v[240:243], v[192:195]
    v_mfma_f32_16x16x32_bf16 v[200:203], v[72:75], v[240:243], v[200:203]
    v_mfma_f32_16x16x32_bf16 v[208:211], v[76:79], v[240:243], v[208:211]
    v_mfma_f32_16x16x32_bf16 v[216:219], v[80:83], v[240:243], v[216:219]
    v_mfma_f32_16x16x32_bf16 v[224:227], v[84:87], v[240:243], v[224:227]
h3_n2:
    s_bitcmp1_b32 s43, 3
    s_cbranch_scc0 h3_n3
    ds_read_b128 v[228:231], v252 offset:4608
    ds_read_b128 v[232:235], v252 offset:5632
    ds_read_b128 v[236:239], v252 offset:6656
    ds_read_b128 v[240:243], v252 offset:7680
    ds_read_b64 v[244:245], v253 offset:4608
    s_waitcnt lgkmcnt(3)
    v_max3_u32 v1, v228, v229, v230
    v_max3_u32 v1, v231, v232, v1
    v_max3_u32 v1, v233, v234, v1
    s_waitcnt lgkmcnt(0)
    v_max3_u32 v1, v235, v236, v1
    v_max3_u32 v1, v237, v238, v1
    v_max3_u32 v1, v239, v240, v1
    v_max3_u32 v1, v241, v242, v1
    v_max3_u32 v1, v243, v244, v1
    v_max_u32 v1, v245, v1
    v_cmp_eq_u32 vcc, s46, v1
    s_nop 1
    s_cbranch_vccnz h3_n3
    s_bitset1_b32 s42, 3
    v_mfma_f32_16x16x32_bf16 v[192:195], v[88:91], v[228:231], v[192:195]
    v_mfma_f32_16x16x32_bf16 v[200:203], v[92:95], v[228:231], v[200:203]
    v_mfma_f32_16x16x32_bf16 v[208:211], v[96:99], v[228:231], v[208:211]
    v_mfma_f32_16x16x32_bf16 v[216:219], v[100:103], v[228:231], v[216:219]
    v_mfma_f32_16x16x32_bf16 v[224:227], v[104:107], v[228:231], v[224:227]
    v_mfma_f32_16x16x32_bf16 v[192:195], v[108:111], v[232:235], v[192:195]
    v_mfma_f32_16x16x32_bf16 v[200:203], v[112:115], v[232:235], v[200:203]
    v_mfma_f32_16x16x32_bf16 v[208:211], v[116:119], v[232:235], v[208:211]
    v_mfma_f32_16x16x32_bf16 v[216:219], v[120:123], v[232:235], v[216:219]
    v_mfma_f32_16x16x32_bf16 v[224:227], v[124:127], v[232:235], v[224:227]
    v_mfma_f32_16x16x32_bf16 v[192:195], v[128:131], v[236:239], v[192:195]
    v_mfma_f32_16x16x32_bf16 v[200:203], v[132:135], v[236:239], v[200:203]
    v_mfma_f32_16x16x32_bf16 v[208:211], v[136:139], v[236:239], v[208:211]
    v_mfma_f32_16x16x32_bf16 v[216:219], v[140:143], v[236:239], v[216:219]
    v_mfma_f32_16x16x32_bf16 v[224:227], v[144:147], v[236:239], v[224:227]
    v_mfma_f32_16x16x32_bf16 v[192:195], v[148:151], v[240:243], v[192:195]
    v_mfma_f32_16x16x32_bf16 v[200:203], v[152:155], v[240:243], v[200:203]
    v_mfma_f32_16x16x32_bf16 v[208:211], v[156:159], v[240:243], v[208:211]
    v_mfma_f32_16x16x32_bf16 v[216:219], v[160:163], v[240:243], v[216:219]
    v_mfma_f32_16x16x32_bf16 v[224:227], v[164:167], v[240:243], v[224:227]
h3_n3:
    s_cmp_eq_u32 s42, 15
    s_cbranch_scc1 h3_done
    s_sub_u32 s48, s48, 1
    s_cmp_lt_i32 s48, 0
    s_cbranch_scc1 h3_done
    s_or_b32 s37, s62, s43
    s_cbranch_scc1 h3_round
    s_sleep 1
    s_branch h3_round
h3_done:
    s_waitcnt vmcnt(0)
    v_add_u32 v1, s74, v3
    ds_read_b32 v228, v1 offset:4096
    ds_read_b32 v229, v1 offset:4160
    ds_read_b32 v230, v1 offset:4224
    ds_read_b32 v231, v1 offset:4288
    v_add_u32 v1, s75, v3
    ds_read_b32 v232, v1 offset:4096
    ds_read_b32 v233, v1 offset:4160
    ds_read_b32 v234, v1 offset:4224
    ds_read_b32 v235, v1 offset:4288
    s_lshl_b32 s40, s49, 6
    v_add_u32 v1, s40, v0
    s_and_b32 s37, s88, 60
    s_add_u32 s37, s37, s88
    s_mul_i32 s37, s37, 18432
    s_mul_i32 s38, s89, 288
    s_add_u32 s37, s37, s38
    v_mul_u32_u24 v38, 3641, v1
    v_lshrrev_b32 v38, 16, v38
    v_mul_u32_u24 v39, 18, v38
    v_sub_u32 v39, v1, v39
    v_mul_u32_u24 v32, 592, v38
    v_lshl_add_u32 v32, v39, 5, v32
    v_add_u32 v36, 75776, v32
    v_and_b32 v34, 16, v38
    v_mad_u32_u24 v38, v34, 3, v38
    v_mul_u32_u24 v34, 1152, v38
    v_lshl_add_u32 v34, v39, 4, v34
    v_add_u32 v1, 512, v1
    v_mul_u32_u24 v38, 3641, v1
    v_lshrrev_b32 v38, 16, v38
    v_mul_u32_u24 v39, 18, v38
    v_sub_u32 v39, v1, v39
    v_mul_u32_u24 v33, 592, v38
    v_lshl_add_u32 v33, v39, 5, v33
    v_add_u32 v37, 75776, v33
    v_and_b32 v35, 16, v38
    v_mad_u32_u24 v38, v35, 3, v38
    v_mul_u32_u24 v35, 1152, v38
    v_lshl_add_u32 v35, v39, 4, v35
    s_waitcnt lgkmcnt(0)
    v_mfma_f32_16x16x32_bf16 v[188:191], v[168:171], v[228:231], v[188:191]
    v_mfma_f32_16x16x32_bf16 v[192:195], v[168:171], v[232:235], v[192:195]
    v_mfma_f32_16x16x32_bf16 v[196:199], v[172:175], v[228:231], v[196:199]
    v_mfma_f32_16x16x32_bf16 v[200:203], v[172:175], v[232:235], v[200:203]
    v_mfma_f32_16x16x32_bf16 v[204:207], v[176:179], v[228:231], v[204:207]
    v_mfma_f32_16x16x32_bf16 v[208:211], v[176:179], v[232:235], v[208:211]
    v_mfma_f32_16x16x32_bf16 v[212:215], v[180:183], v[228:231], v[212:215]
    v_mfma_f32_16x16x32_bf16 v[216:219], v[180:183], v[232:235], v[216:219]
    v_mfma_f32_16x16x32_bf16 v[220:223], v[184:187], v[228:231], v[220:223]
    v_mfma_f32_16x16x32_bf16 v[224:227], v[184:187], v[232:235], v[224:227]
    s_nop 7
    ds_write_b128 v6, v[188:191] offset:0
    ds_write_b128 v6, v[192:195] offset:9472
    ds_write_b128 v6, v[196:199] offset:64
    ds_write_b128 v6, v[200:203] offset:9536
    ds_write_b128 v6, v[204:207] offset:128
    ds_write_b128 v6, v[208:211] offset:9600
    ds_write_b128 v6, v[212:215] offset:192
    ds_write_b128 v6, v[216:219] offset:9664
    ds_write_b128 v6, v[220:223] offset:256
    ds_write_b128 v6, v[224:227] offset:9728
    s_branch k_final
k_ldblk:
    s_add_u32 s77, s77, 2
    s_cmp_ge_u32 s77, 9
    s_cselect_b32 s37, 0, 7
    s_cselect_b32 s39, 1, 0
    s_add_u32 s37, s37, s77
    s_and_b32 s37, s37, 7
    s_xor_b32 s37, s37, s34
    s_lshl_b32 s37, s37, 1
    s_add_u32 s37, s37, s39
    s_mul_i32 s38, s37, 9472
    s_add_u32 s38, s38, s47
    s_and_b32 s37, s77, 7
    s_mul_i32 s37, s37, 9472
    s_add_u32 s37, s37, s45
    s_add_u32 m0, s37, 0
    s_add_u32 s39, s38, 0
    buffer_load_dwordx4 v7, s[28:31], s39 offen offset:0 sc1 lds
    buffer_load_dwordx4 v7, s[28:31], s39 offen offset:1024 sc1 lds
    buffer_load_dwordx4 v7, s[28:31], s39 offen offset:2048 sc1 lds
    buffer_load_dwordx4 v7, s[28:31], s39 offen offset:3072 sc1 lds
    s_add_u32 m0, s37, 4096
    s_add_u32 s39, s38, 4096
    buffer_load_dwordx4 v7, s[28:31], s39 offen offset:0 sc1 lds
    buffer_load_dwordx4 v7, s[28:31], s39 offen offset:1024 sc1 lds
    buffer_load_dwordx4 v7, s[28:31], s39 offen offset:2048 sc1 lds
    buffer_load_dwordx4 v7, s[28:31], s39 offen offset:3072 sc1 lds
    s_add_u32 m0, s37, 8192
    s_add_u32 s39, s38, 8192
    buffer_load_dwordx4 v7, s[28:31], s39 offen offset:0 sc1 lds
    s_mov_b64 exec, 0xffff
    buffer_load_dwordx4 v7, s[28:31], s39 offen offset:1024 sc1 lds
    s_mov_b64 exec, -1
    s_setpc_b64 s[50:51]
k_compute:
    s_mov_b32 s30, 18874368
    s_mov_b32 s31, 0x00020000
    s_mov_b32 s86, 2359296
    s_mov_b32 s87, 0x00020000
    s_mov_b32 s26, 256
    s_mov_b32 s27, 0x00020000
    s_mov_b32 s18, 663552
    s_mov_b32 s19, 0x00020000
    s_lshl_b32 s79, s33, 1
    s_add_u32 s79, s79, s93
    s_mul_i32 s47, s79, 151552
    s_waitcnt lgkmcnt(0)
    v_mov_b32 v128, 0
    v_and_b32 v64, 15, v0
    v_lshrrev_b32 v65, 4, v0
    v_bfe_u32 v66, v0, 1, 3
    v_xor_b32 v66, v66, v65
    v_lshlrev_b32 v66, 4, v66
    v_lshlrev_b32 v67, 7, v64
    s_lshl_b32 s37, s94, 12
    s_lshl_b32 s38, s93, 11
    s_add_u32 s37, s37, s38
    s_add_u32 s37, s37, 98304
    v_add_u32 v67, s37, v67
    v_add_u32 v2, v67, v66
    v_xor_b32 v66, 64, v66
    v_add_u32 v3, v67, v66
    v_xor_b32 v20, 2048, v2
    v_xor_b32 v21, 2048, v3
    v_bfe_u32 v66, v0, 2, 2
    v_lshl_add_u32 v66, v65, 3, v66
    v_lshlrev_b32 v66, 8, v66
    v_bfe_u32 v68, v0, 2, 3
    v_lshlrev_b32 v68, 5, v68
    v_and_b32 v67, 3, v0
    v_lshlrev_b32 v67, 3, v67
    s_mul_i32 s38, s93, 40
    s_mov_b32 s37, 4028657856
    v_lshrrev_b32 v69, v67, s37
    v_and_b32 v69, 0xff, v69
    v_xor_b32 v69, v69, v68
    v_add_u32 v1, v66, v69
    v_add_u32 v67, s38, v67
    v_lshrrev_b32 v69, 3, v67
    v_and_b32 v69, 8, v69
    v_add_u32 v67, v67, v69
    v_add_u32 v69, 80, v67
    v_xor_b32 v69, v69, v68
    v_add_u32 v4, v66, v69
    v_add_u32 v69, 0, v67
    v_xor_b32 v69, v69, v68
    v_add_u32 v5, v66, v69
    v_add_u32 v69, 160, v67
    v_xor_b32 v69, v69, v68
    v_add_u32 v9, v66, v69
    v_mov_b32 v129, 0
    v_mov_b32 v130, 0
    v_mov_b32 v131, 0
    v_mov_b32 v132, 0
    v_mov_b32 v133, 0
    v_mov_b32 v134, 0
    v_mov_b32 v135, 0
    v_mov_b32 v136, 0
    v_mov_b32 v137, 0
    v_mov_b32 v138, 0
    v_mov_b32 v139, 0
    v_mov_b32 v140, 0
    v_mov_b32 v141, 0
    v_mov_b32 v142, 0
    v_mov_b32 v143, 0
    v_mov_b32 v144, 0
    v_mov_b32 v145, 0
    v_mov_b32 v146, 0
    v_mov_b32 v147, 0
    v_mov_b32 v148, 0
    v_mov_b32 v149, 0
    v_mov_b32 v150, 0
    v_mov_b32 v151, 0
    v_mov_b32 v152, 0
    v_mov_b32 v153, 0
    v_mov_b32 v154, 0
    v_mov_b32 v155, 0
    v_mov_b32 v160, 0
    v_mov_b32 v161, 0
    v_mov_b32 v162, 0
    v_mov_b32 v163, 0
    v_mov_b32 v164, 0
    v_mov_b32 v165, 0
    v_mov_b32 v166, 0
    v_mov_b32 v167, 0
    v_mov_b32 v168, 0
    v_mov_b32 v169, 0
    v_mov_b32 v170, 0
    v_mov_b32 v171, 0
    v_mov_b32 v172, 0
    v_mov_b32 v173, 0
    v_mov_b32 v174, 0
    v_mov_b32 v175, 0
    v_mov_b32 v176, 0
    v_mov_b32 v177, 0
    v_mov_b32 v178, 0
    v_mov_b32 v179, 0
    v_mov_b32 v180, 0
    v_mov_b32 v181, 0
    v_mov_b32 v182, 0
    v_mov_b32 v183, 0
    v_mov_b32 v184, 0
    v_mov_b32 v185, 0
    v_mov_b32 v186, 0
    v_mov_b32 v187, 0
    v_mov_b32 v192, 0
    v_mov_b32 v193, 0
    v_mov_b32 v194, 0
    v_mov_b32 v195, 0
    v_mov_b32 v196, 0
    v_mov_b32 v197, 0
    v_mov_b32 v198, 0
    v_mov_b32 v199, 0
    v_mov_b32 v200, 0
    v_mov_b32 v201, 0
    v_mov_b32 v202, 0
    v_mov_b32 v203, 0
    v_mov_b32 v204, 0
    v_mov_b32 v205, 0
    v_mov_b32 v206, 0
    v_mov_b32 v207, 0
    v_mov_b32 v208, 0
    v_mov_b32 v209, 0
    v_mov_b32 v210, 0
    v_mov_b32 v211, 0
    v_mov_b32 v212, 0
    v_mov_b32 v213, 0
    v_mov_b32 v214, 0
    v_mov_b32 v215, 0
    v_mov_b32 v216, 0
    v_mov_b32 v217, 0
    v_mov_b32 v218, 0
    v_mov_b32 v219, 0
    v_mov_b32 v224, 0
    v_mov_b32 v225, 0
    v_mov_b32 v226, 0
    v_mov_b32 v227, 0
    v_mov_b32 v228, 0
    v_mov_b32 v229, 0
    v_mov_b32 v230, 0
    v_mov_b32 v231, 0
    v_mov_b32 v232, 0
    v_mov_b32 v233, 0
    v_mov_b32 v234, 0
    v_mov_b32 v235, 0
    v_mov_b32 v236, 0
    v_mov_b32 v237, 0
    v_mov_b32 v238, 0
    v_mov_b32 v239, 0
    v_mov_b32 v240, 0
    v_mov_b32 v241, 0
    v_mov_b32 v242, 0
    v_mov_b32 v243, 0
    v_mov_b32 v244, 0
    v_mov_b32 v245, 0
    v_mov_b32 v246, 0
    v_mov_b32 v247, 0
    v_mov_b32 v248, 0
    v_mov_b32 v249, 0
    v_mov_b32 v250, 0
    v_mov_b32 v251, 0
    s_mul_i32 s45, s93, 75776
    s_mul_i32 s44, s94, 9472
    s_add_u32 s44, s44, s45
    s_mul_i32 s43, s32, 5120
    s_add_u32 s43, s43, 49152
    v_lshrrev_b32 v66, 2, v64
    v_and_b32 v67, 3, v0
    v_lshl_add_u32 v68, v66, 3, v67
    v_lshrrev_b32 v69, 5, v0
    v_lshlrev_b32 v69, 9, v69
    v_and_b32 v12, 16, v0
    v_lshrrev_b32 v12, 1, v12
    v_add_u32 v69, v69, v12
    v_lshl_add_u32 v11, v68, 4, v69
    s_lshl_b32 s37, s94, 11
    s_add_u32 s37, s37, s45
    v_add_u32 v11, s37, v11
    v_lshl_add_u32 v12, v64, 4, v69
    v_add_u32 v12, s43, v12
    v_mul_u32_u24 v13, 304, v65
    v_lshl_add_u32 v13, v64, 4, v13
    s_mul_i32 s37, s94, 2432
    s_add_u32 s37, s37, s45
    v_add_u32 v13, s37, v13
    s_mul_i32 s39, s94, 2432
    s_mul_i32 s40, s94, 5120
    v_mul_u32_u24 v70, 304, v66
    v_lshl_add_u32 v70, v67, 1, v70
    s_add_u32 s37, s39, 4864
    v_add_u32 v70, s37, v70
    s_lshl_b32 s37, s94, 3
    s_add_u32 s37, s37, 4096
    s_add_u32 s38, s40, 52224
    v_lshlrev_b32 v69, 9, v65
    v_add_u32 v69, s38, v69
    v_mov_b32 v74, s37
    v_cmp_eq_u32 vcc, 1, v65
    v_mov_b32 v71, 64
    v_mov_b32 v72, 4
    v_cndmask_b32 v69, v69, v74, vcc
    v_lshl_add_u32 v69, v68, 4, v69
    v_cmp_eq_u32 vcc, 0, v65
    v_mov_b32 v73, 2
    v_mov_b32 v67, 1216
    v_cndmask_b32 v70, v69, v70, vcc
    v_cndmask_b32 v71, v71, 8, vcc
    v_cndmask_b32 v72, v72, v67, vcc
    v_cndmask_b32 v73, v73, 16, vcc
    v_cmp_gt_u32 vcc, 2, v65
    v_mov_b32 v74, 10240
    v_mov_b32 v67, 75776
    v_cndmask_b32 v74, v74, v67, vcc
    v_mov_b32 v69, 8
    v_mov_b32 v67, 9472
    v_cndmask_b32 v69, v69, v67, vcc
    v_mul_u32_u24 v67, s93, v71
    v_add_u32 v156, v70, v67
    v_sub_u32 v67, v71, v67
    v_add3_u32 v158, v70, v67, v74
    v_add_u32 v157, v156, v73
    v_add_u32 v159, v158, v73
    v_add_u32 v188, v156, v72
    v_add_u32 v220, v156, v69
    v_add_u32 v252, v188, v69
    v_add_u32 v189, v157, v72
    v_add_u32 v221, v157, v69
    v_add_u32 v253, v189, v69
    v_add_u32 v190, v158, v72
    v_add_u32 v222, v158, v69
    v_add_u32 v254, v190, v69
    v_add_u32 v191, v159, v72
    v_add_u32 v223, v159, v69
    v_add_u32 v255, v191, v69
    s_and_b32 s37, s78, 2
    s_lshl_b32 s37, s37, 2
    v_mov_b32 v67, s37
    v_cndmask_b32 v67, v67, 0, vcc
    v_xor_b32 v156, v67, v156
    v_xor_b32 v157, v67, v157
    v_xor_b32 v158, v67, v158
    v_xor_b32 v159, v67, v159
    v_xor_b32 v188, v67, v188
    v_xor_b32 v189, v67, v189
    v_xor_b32 v190, v67, v190
    v_xor_b32 v191, v67, v191
    v_xor_b32 v220, v67, v220
    v_xor_b32 v221, v67, v221
    v_xor_b32 v222, v67, v222
    v_xor_b32 v223, v67, v223
    v_xor_b32 v252, v67, v252
    v_xor_b32 v253, v67, v253
    v_xor_b32 v254, v67, v254
    v_xor_b32 v255, v67, v255
    v_cmp_eq_u32 vcc, 2, v65
    v_mov_b32 v24, 1.0
    v_mov_b32 v66, 0x3eae1a93
    v_cndmask_b32 v24, v24, v66, vcc
    v_and_b32 v66, 16, v0
    v_lshrrev_b32 v66, 2, v66
    v_add_u32 v66, v66, v68
    v_lshlrev_b32 v25, 4, v66
    s_add_u32 s38, s43, 4096
    v_add_u32 v25, s38, v25
    v_and_b32 v64, 31, v0
    v_lshrrev_b32 v65, 5, v0
    v_mul_u32_u24 v67, 304, v65
    v_lshl_add_u32 v67, v64, 4, v67
    v_add_u32 v67, s45, v67
    v_cmp_gt_u32 vcc, 19, v64
    v_mov_b32 v8, 163840
    v_lshl_add_u32 v6, v0, 4, s45
    v_cndmask_b32 v8, v8, v67, vcc
    v_lshl_add_u32 v7, v64, 4, s45
    v_mov_b32 v10, 0xdddddddd
    v_lshl_add_u32 v19, v65, 2, v25
    s_mov_b32 s54, 0
    s_mov_b32 s76, 0
    v_mul_u32_u24 v22, 304, v0
    v_add_u32 v22, s44, v22
    s_and_b32 s37, s78, 2
    s_lshl_b32 s37, s37, 10
    s_add_u32 s38, s43, s37
    v_lshl_add_u32 v23, v0, 4, s38
    s_lshl_b32 s6, s37, 1
    s_sub_u32 s6, 2048, s6
    s_mul_i32 s37, s94, 27648
    s_add_u32 s37, s37, s45
    v_lshl_add_u32 v18, v0, 4, s37
    v_bfe_u32 v66, v0, 4, 1
    v_xor_b32 v66, s93, v66
    v_and_b32 v67, 15, v0
    v_mul_u32_u24 v14, 73728, v66
    v_lshl_add_u32 v15, v67, 2, v14
    v_lshl_add_u32 v14, v67, 4, v14
    v_lshl_add_u32 v14, v65, 8, v14
    s_and_b32 s39, s78, 1
    v_xor_b32 v66, s39, v65
    v_mul_u32_u24 v66, 147456, v66
    v_add_u32 v15, v15, v66
    s_lshl_b32 s38, s34, 1
    s_add_u32 s38, s38, s94
    s_lshl_b32 s38, s38, 9
    s_add_u32 s38, s38, s79
    s_mul_i32 s38, s38, 576
    s_and_b32 s40, s79, 7
    s_lshl_b32 s37, s40, 6
    s_sub_u32 s38, s38, s37
    s_add_u32 s4, s38, 10485760
    s_add_u32 s5, s4, 36864
    s_mul_i32 s37, s39, 147456
    s_sub_u32 s38, 147456, s37
    s_add_u32 s56, s4, s37
    s_add_u32 s57, s4, s38
    s_add_u32 s58, s5, s37
    s_add_u32 s59, s5, s38
    s_mul_i32 s40, s40, 448
    s_sub_u32 s40, 4096, s40
    s_add_u32 s4, s4, s40
    s_add_u32 s5, s5, s40
    s_cmp_ge_u32 s33, 16
    s_mov_b32 s60, 0xbfb8aa3b
    s_cselect_b32 s60, 0x3fb8aa3b, s60
    s_mov_b32 s61, 0x2b800000
    s_mov_b32 s64, 0x53800000
    s_mov_b32 s65, 0x3eae1a93
    s_and_b32 s88, s2, 7
    s_lshr_b32 s37, s2, 5
    s_lshl_b32 s37, s37, 3
    s_add_u32 s88, s88, s37
    s_lshr_b32 s89, s2, 3
    s_and_b32 s89, s89, 3
    s_lshl_b32 s90, s88, 7
    s_lshl_b32 s40, s32, 3
    s_add_u32 s90, s90, s40
    s_mul_i32 s90, s90, 576
    s_add_u32 s90, s90, 10485760
    s_lshl_b32 s91, s89, 6
    s_add_u32 s91, s91, s40
    s_mul_i32 s91, s91, 4608
    s_add_u32 s91, s91, 15728640
    s_lshl_b32 s92, s89, 3
    s_add_u32 s92, s92, s32
    s_mul_i32 s92, s92, 4608
    s_add_u32 s92, s92, 17301504
    s_mul_i32 s74, s93, 75776
    s_mul_i32 s40, s94, 9216
    s_add_u32 s74, s74, s40
    s_add_u32 s74, s74, 56832
    s_mul_i32 s75, s32, 9216
    s_add_u32 s75, s75, 94720
    s_add_u32 s40, s89, 0
    s_and_b32 s40, s40, 1
    s_mul_i32 s66, s40, 18432
    s_add_u32 s66, s66, s90
    s_add_u32 s68, s66, 36864
    s_mul_i32 s70, s40, 147456
    s_add_u32 s70, s70, s91
    s_add_u32 s40, s89, 1
    s_and_b32 s40, s40, 1
    s_mul_i32 s67, s40, 18432
    s_add_u32 s67, s67, s90
    s_add_u32 s69, s67, 36864
    s_mul_i32 s71, s40, 147456
    s_add_u32 s71, s71, s91
    v_and_b32 v64, 15, v0
    v_lshrrev_b32 v65, 5, v0
    v_bfe_u32 v66, v0, 4, 1
    v_mul_u32_u24 v16, 4608, v65
    v_lshl_add_u32 v16, v66, 8, v16
    v_lshl_add_u32 v16, v64, 4, v16
    v_xor_b32 v65, s89, v65
    v_and_b32 v65, 1, v65
    v_lshl_add_u32 v66, v65, 3, v66
    v_mul_u32_u24 v17, 2304, v66
    v_lshl_add_u32 v17, v64, 4, v17
    s_mov_b32 s62, 4294918144
    s_mov_b32 s63, 8192
    s_mov_b32 s55, 4294934528
    s_mov_b32 s77, 16384
    s_cmp_eq_u32 s32, 0
    s_cselect_b32 s42, 4, 100
    s_cbranch_scc0 k_norst
    s_lshl_b32 s37, s33, 12
    s_lshl_b32 s38, s34, 8
    s_add_u32 s37, s37, s38
    s_add_u32 s37, s37, 17563648
    v_lshlrev_b32 v75, 7, v0
    v_mov_b32 v76, 0
    v_mov_b32 v77, 0
    s_mov_b64 exec, 3
    buffer_store_dwordx2 v[76:77], v75, s[28:31], s37 offen sc1
    buffer_store_dwordx2 v[76:77], v75, s[28:31], s37 offen offset:2048 sc1
    s_mov_b64 exec, -1
k_norst:
    s_barrier
    ds_read_b128 v[96:99], v2
    ds_read_b128 v[100:103], v20
    ds_read_b128 v[104:107], v3
    ds_read_b128 v[108:111], v21
    s_add_u32 s76, s76, 1
    s_cmp_eq_u32 s76, 7
    s_cselect_b32 s76, 0, s76
    s_cselect_b32 s38, s62, s63
    v_add_u32 v2, s38, v2
    v_add_u32 v3, s38, v3
    v_add_u32 v20, s38, v20
    v_add_u32 v21, s38, v21
    ds_read_b64_tr_b16 v[32:33], v4 offset:0
    ds_read_b64_tr_b16 v[34:35], v4 offset:1024
    ds_read_b64_tr_b16 v[36:37], v5 offset:0
    ds_read_b64_tr_b16 v[38:39], v5 offset:1024
    ds_read_b64_tr_b16 v[40:41], v9 offset:0
    ds_read_b64_tr_b16 v[42:43], v9 offset:1024
    ds_read_b64_tr_b16 v[44:45], v1 offset:0
    ds_read_b64_tr_b16 v[46:47], v1 offset:1024
    ds_read_b64_tr_b16 v[48:49], v4 offset:8192
    ds_read_b64_tr_b16 v[50:51], v4 offset:9216
    ds_read_b64_tr_b16 v[52:53], v5 offset:8192
    ds_read_b64_tr_b16 v[54:55], v5 offset:9216
    ds_read_b64_tr_b16 v[56:57], v9 offset:8192
    ds_read_b64_tr_b16 v[58:59], v9 offset:9216
    ds_read_b64_tr_b16 v[60:61], v1 offset:8192
    ds_read_b64_tr_b16 v[62:63], v1 offset:9216
    s_mov_b32 s46, 8
    s_waitcnt lgkmcnt(0)
k_p1:
    s_barrier
    s_waitcnt lgkmcnt(8)
    v_mfma_f32_16x16x32_bf16 v[128:131], v[32:35], v[96:99], v[128:131]
    ds_read_b128 v[112:115], v2
    v_mfma_f32_16x16x32_bf16 v[144:147], v[32:35], v[100:103], v[144:147]
    ds_read_b128 v[116:119], v20
    v_mfma_f32_16x16x32_bf16 v[132:135], v[36:39], v[96:99], v[132:135]
    ds_read_b128 v[120:123], v3
    v_mfma_f32_16x16x32_bf16 v[148:151], v[36:39], v[100:103], v[148:151]
    ds_read_b128 v[124:127], v21
    v_mfma_f32_16x16x32_bf16 v[136:139], v[96:99], v[40:43], v[136:139]
    s_add_u32 s76, s76, 1
    v_mfma_f32_16x16x32_bf16 v[152:155], v[100:103], v[40:43], v[152:155]
    s_cmp_eq_u32 s76, 7
    v_mfma_f32_16x16x32_bf16 v[140:143], v[44:47], v[96:99], v[140:143]
    s_waitcnt lgkmcnt(4)
    v_mfma_f32_16x16x32_bf16 v[128:131], v[48:51], v[104:107], v[128:131]
    s_cselect_b32 s76, 0, s76
    v_mfma_f32_16x16x32_bf16 v[144:147], v[48:51], v[108:111], v[144:147]
    s_cselect_b32 s38, s62, s63
    v_mfma_f32_16x16x32_bf16 v[132:135], v[52:55], v[104:107], v[132:135]
    v_add_u32 v2, s38, v2
    v_mfma_f32_16x16x32_bf16 v[148:151], v[52:55], v[108:111], v[148:151]
    v_add_u32 v3, s38, v3
    v_mfma_f32_16x16x32_bf16 v[136:139], v[104:107], v[56:59], v[136:139]
    v_add_u32 v20, s38, v20
    v_mfma_f32_16x16x32_bf16 v[152:155], v[108:111], v[56:59], v[152:155]
    v_add_u32 v21, s38, v21
    v_mfma_f32_16x16x32_bf16 v[140:143], v[60:63], v[104:107], v[140:143]
    s_waitcnt lgkmcnt(0)
    v_mfma_f32_16x16x32_bf16 v[160:163], v[32:35], v[112:115], v[160:163]
    ds_read_b128 v[96:99], v2
    v_mfma_f32_16x16x32_bf16 v[176:179], v[32:35], v[116:119], v[176:179]
    ds_read_b128 v[100:103], v20
    v_mfma_f32_16x16x32_bf16 v[164:167], v[36:39], v[112:115], v[164:167]
    ds_read_b128 v[104:107], v3
    v_mfma_f32_16x16x32_bf16 v[180:183], v[36:39], v[116:119], v[180:183]
    ds_read_b128 v[108:111], v21
    v_mfma_f32_16x16x32_bf16 v[168:171], v[112:115], v[40:43], v[168:171]
    s_add_u32 s76, s76, 1
    v_mfma_f32_16x16x32_bf16 v[184:187], v[116:119], v[40:43], v[184:187]
    s_cmp_eq_u32 s76, 7
    v_mfma_f32_16x16x32_bf16 v[172:175], v[44:47], v[112:115], v[172:175]
    s_cselect_b32 s76, 0, s76
    v_mfma_f32_16x16x32_bf16 v[160:163], v[48:51], v[120:123], v[160:163]
    s_cselect_b32 s38, s62, s63
    v_mfma_f32_16x16x32_bf16 v[176:179], v[48:51], v[124:127], v[176:179]
    v_add_u32 v2, s38, v2
    v_mfma_f32_16x16x32_bf16 v[164:167], v[52:55], v[120:123], v[164:167]
    v_add_u32 v3, s38, v3
    v_mfma_f32_16x16x32_bf16 v[180:183], v[52:55], v[124:127], v[180:183]
    v_add_u32 v20, s38, v20
    s_add_u32 s54, s54, 1
    v_mfma_f32_16x16x32_bf16 v[168:171], v[120:123], v[56:59], v[168:171]
    v_add_u32 v21, s38, v21
    s_cmp_eq_u32 s54, 3
    v_mfma_f32_16x16x32_bf16 v[184:187], v[124:127], v[56:59], v[184:187]
    s_cselect_b32 s54, 0, s54
    v_mfma_f32_16x16x32_bf16 v[172:175], v[60:63], v[120:123], v[172:175]
    s_cselect_b32 s39, s55, s77
    s_waitcnt lgkmcnt(0)
    s_barrier
    v_mfma_f32_16x16x32_bf16 v[192:195], v[32:35], v[96:99], v[192:195]
    ds_read_b128 v[112:115], v2
    v_mfma_f32_16x16x32_bf16 v[208:211], v[32:35], v[100:103], v[208:211]
    ds_read_b128 v[116:119], v20
    v_mfma_f32_16x16x32_bf16 v[196:199], v[36:39], v[96:99], v[196:199]
    ds_read_b128 v[120:123], v3
    v_mfma_f32_16x16x32_bf16 v[212:215], v[36:39], v[100:103], v[212:215]
    ds_read_b128 v[124:127], v21
    v_mfma_f32_16x16x32_bf16 v[200:203], v[96:99], v[40:43], v[200:203]
    s_add_u32 s76, s76, 1
    v_mfma_f32_16x16x32_bf16 v[216:219], v[100:103], v[40:43], v[216:219]
    s_cmp_eq_u32 s76, 7
    v_mfma_f32_16x16x32_bf16 v[204:207], v[44:47], v[96:99], v[204:207]
    s_cselect_b32 s76, 0, s76
    v_mfma_f32_16x16x32_bf16 v[192:195], v[48:51], v[104:107], v[192:195]
    s_cselect_b32 s38, s62, s63
    v_mfma_f32_16x16x32_bf16 v[208:211], v[48:51], v[108:111], v[208:211]
    v_add_u32 v2, s38, v2
    v_mfma_f32_16x16x32_bf16 v[196:199], v[52:55], v[104:107], v[196:199]
    v_add_u32 v3, s38, v3
    v_mfma_f32_16x16x32_bf16 v[212:215], v[52:55], v[108:111], v[212:215]
    v_add_u32 v20, s38, v20
    v_add_u32 v4, s39, v4
    v_mfma_f32_16x16x32_bf16 v[200:203], v[104:107], v[56:59], v[200:203]
    v_add_u32 v21, s38, v21
    v_add_u32 v5, s39, v5
    v_mfma_f32_16x16x32_bf16 v[216:219], v[108:111], v[56:59], v[216:219]
    v_add_u32 v9, s39, v9
    v_mfma_f32_16x16x32_bf16 v[204:207], v[60:63], v[104:107], v[204:207]
    v_add_u32 v1, s39, v1
    s_waitcnt lgkmcnt(0)
    ds_read_b128 v[96:99], v2
    v_mfma_f32_16x16x32_bf16 v[224:227], v[32:35], v[112:115], v[224:227]
    ds_read_b128 v[100:103], v20
    ds_read_b128 v[104:107], v3
    v_mfma_f32_16x16x32_bf16 v[240:243], v[32:35], v[116:119], v[240:243]
    ds_read_b128 v[108:111], v21
    ds_read_b64_tr_b16 v[32:33], v4 offset:0
    v_mfma_f32_16x16x32_bf16 v[228:231], v[36:39], v[112:115], v[228:231]
    ds_read_b64_tr_b16 v[34:35], v4 offset:1024
    s_add_u32 s76, s76, 1
    v_mfma_f32_16x16x32_bf16 v[244:247], v[36:39], v[116:119], v[244:247]
    ds_read_b64_tr_b16 v[36:37], v5 offset:0
    s_cmp_eq_u32 s76, 7
    v_mfma_f32_16x16x32_bf16 v[232:235], v[112:115], v[40:43], v[232:235]
    ds_read_b64_tr_b16 v[38:39], v5 offset:1024
    s_cselect_b32 s76, 0, s76
    v_mfma_f32_16x16x32_bf16 v[248:251], v[116:119], v[40:43], v[248:251]
    ds_read_b64_tr_b16 v[40:41], v9 offset:0
    s_cselect_b32 s38, s62, s63
    v_mfma_f32_16x16x32_bf16 v[236:239], v[44:47], v[112:115], v[236:239]
    ds_read_b64_tr_b16 v[42:43], v9 offset:1024
    ds_read_b64_tr_b16 v[44:45], v1 offset:0
    v_mfma_f32_16x16x32_bf16 v[224:227], v[48:51], v[120:123], v[224:227]
    ds_read_b64_tr_b16 v[46:47], v1 offset:1024
    v_add_u32 v2, s38, v2
    v_mfma_f32_16x16x32_bf16 v[240:243], v[48:51], v[124:127], v[240:243]
    ds_read_b64_tr_b16 v[48:49], v4 offset:8192
    v_add_u32 v3, s38, v3
    v_mfma_f32_16x16x32_bf16 v[228:231], v[52:55], v[120:123], v[228:231]
    ds_read_b64_tr_b16 v[50:51], v4 offset:9216
    v_add_u32 v20, s38, v20
    v_mfma_f32_16x16x32_bf16 v[244:247], v[52:55], v[124:127], v[244:247]
    ds_read_b64_tr_b16 v[52:53], v5 offset:8192
    v_add_u32 v21, s38, v21
    v_mfma_f32_16x16x32_bf16 v[232:235], v[120:123], v[56:59], v[232:235]
    ds_read_b64_tr_b16 v[54:55], v5 offset:9216
    s_sub_u32 s46, s46, 1
    v_mfma_f32_16x16x32_bf16 v[248:251], v[124:127], v[56:59], v[248:251]
    ds_read_b64_tr_b16 v[56:57], v9 offset:8192
    v_mfma_f32_16x16x32_bf16 v[236:239], v[60:63], v[120:123], v[236:239]
    ds_read_b64_tr_b16 v[58:59], v9 offset:9216
    ds_read_b64_tr_b16 v[60:61], v1 offset:8192
    ds_read_b64_tr_b16 v[62:63], v1 offset:9216
    s_waitcnt lgkmcnt(15)
    s_cmp_eq_u32 s46, s42
    s_cbranch_scc1 k_rst
k_rst_ret:
    s_cmp_lg_u32 s46, 0
    s_cbranch_scc1 k_p1
    s_waitcnt vmcnt(0)
    s_barrier
    s_waitcnt lgkmcnt(8)
    v_mfma_f32_16x16x32_bf16 v[128:131], v[32:35], v[96:99], v[128:131]
    ds_read_b128 v[112:115], v2
    v_mov_b32 v92, 0x3f803f80
    v_mfma_f32_16x16x32_bf16 v[144:147], v[32:35], v[100:103], v[144:147]
    ds_read_b128 v[116:119], v20
    v_mov_b32 v93, 0x3f803f80
    v_mfma_f32_16x16x32_bf16 v[132:135], v[36:39], v[96:99], v[132:135]
    ds_read_b128 v[120:123], v3
    v_mov_b32 v94, 0x3f803f80
    v_mfma_f32_16x16x32_bf16 v[148:151], v[36:39], v[100:103], v[148:151]
    ds_read_b128 v[124:127], v21
    v_mov_b32 v95, 0x3f803f80
    v_mfma_f32_16x16x32_bf16 v[136:139], v[96:99], v[40:43], v[136:139]
    s_add_u32 s76, s76, 1
    v_mfma_f32_16x16x32_bf16 v[152:155], v[100:103], v[40:43], v[152:155]
    s_cmp_eq_u32 s76, 7
    v_mfma_f32_16x16x32_bf16 v[140:143], v[44:47], v[96:99], v[140:143]
    s_waitcnt lgkmcnt(4)
    v_mfma_f32_16x16x32_bf16 v[128:131], v[48:51], v[104:107], v[128:131]
    s_cselect_b32 s76, 0, s76
    v_mfma_f32_16x16x32_bf16 v[144:147], v[48:51], v[108:111], v[144:147]
    s_cselect_b32 s38, s62, s63
    v_mfma_f32_16x16x32_bf16 v[132:135], v[52:55], v[104:107], v[132:135]
    v_add_u32 v2, s38, v2
    v_mfma_f32_16x16x32_bf16 v[148:151], v[52:55], v[108:111], v[148:151]
    v_add_u32 v3, s38, v3
    v_mfma_f32_16x16x32_bf16 v[136:139], v[104:107], v[56:59], v[136:139]
    v_add_u32 v20, s38, v20
    v_mfma_f32_16x16x32_bf16 v[152:155], v[108:111], v[56:59], v[152:155]
    v_add_u32 v21, s38, v21
    v_mfma_f32_16x16x32_bf16 v[140:143], v[60:63], v[104:107], v[140:143]
    s_mov_b64 exec, 0xffff
    ds_write_b128 v22, v[92:95] offset:4896
    s_mov_b64 exec, -1
    s_waitcnt lgkmcnt(1)
    v_mfma_f32_16x16x32_bf16 v[160:163], v[32:35], v[112:115], v[160:163]
    ds_read_b128 v[96:99], v2
    ds_read_b128 v[100:103], v20
    v_mfma_f32_16x16x32_bf16 v[176:179], v[32:35], v[116:119], v[176:179]
    ds_read_b128 v[104:107], v3
    ds_read_b128 v[108:111], v21
    v_mfma_f32_16x16x32_bf16 v[164:167], v[36:39], v[112:115], v[164:167]
    s_add_u32 s76, s76, 1
    s_cmp_eq_u32 s76, 7
    s_cselect_b32 s76, 0, s76
    v_mfma_f32_16x16x32_bf16 v[180:183], v[36:39], v[116:119], v[180:183]
    s_cselect_b32 s38, s62, s63
    v_add_u32 v2, s38, v2
    v_add_u32 v3, s38, v3
    v_mfma_f32_16x16x32_bf16 v[168:171], v[112:115], v[40:43], v[168:171]
    v_add_u32 v20, s38, v20
    v_add_u32 v21, s38, v21
    v_mfma_f32_16x16x32_bf16 v[184:187], v[116:119], v[40:43], v[184:187]
    v_cvt_pk_bf16_f32 v64, v128, v129
    v_cvt_pk_bf16_f32 v65, v130, v131
    v_mul_f32 v132, s65, v132
    v_mul_f32 v133, s65, v133
    v_mfma_f32_16x16x32_bf16 v[172:175], v[44:47], v[112:115], v[172:175]
    v_mul_f32 v134, s65, v134
    v_mul_f32 v135, s65, v135
    ds_write_b64 v11, v[64:65] offset:0
    v_cvt_pk_bf16_f32 v68, v132, v133
    v_mfma_f32_16x16x32_bf16 v[160:163], v[48:51], v[120:123], v[160:163]
    v_cvt_pk_bf16_f32 v69, v134, v135
    v_cvt_pk_bf16_f32 v72, v136, v137
    v_cvt_pk_bf16_f32 v73, v138, v139
    ds_write_b64 v12, v[68:69] offset:0
    v_mfma_f32_16x16x32_bf16 v[176:179], v[48:51], v[124:127], v[176:179]
    v_cvt_pk_bf16_f32 v66, v144, v145
    v_cvt_pk_bf16_f32 v67, v146, v147
    v_mul_f32 v148, s65, v148
    v_mul_f32 v149, s65, v149
    v_mfma_f32_16x16x32_bf16 v[164:167], v[52:55], v[120:123], v[164:167]
    v_mul_f32 v150, s65, v150
    v_mul_f32 v151, s65, v151
    ds_write_b64 v11, v[66:67] offset:64
    v_cvt_pk_bf16_f32 v70, v148, v149
    v_mfma_f32_16x16x32_bf16 v[180:183], v[52:55], v[124:127], v[180:183]
    v_cvt_pk_bf16_f32 v71, v150, v151
    v_cvt_pk_bf16_f32 v74, v152, v153
    v_cvt_pk_bf16_f32 v75, v154, v155
    ds_write_b64 v12, v[70:71] offset:256
    v_mfma_f32_16x16x32_bf16 v[168:171], v[120:123], v[56:59], v[168:171]
    ds_write_b128 v13, v[72:75] offset:4608
    v_mul_f32 v140, v24, v140
    v_mul_f32 v141, v24, v141
    v_mul_f32 v142, v24, v142
    v_mfma_f32_16x16x32_bf16 v[184:187], v[124:127], v[56:59], v[184:187]
    v_mul_f32 v143, v24, v143
    v_cvt_pk_bf16_f32 v76, v140, v141
    v_cvt_pk_bf16_f32 v77, v142, v143
    ds_write_b16 v156, v76
    v_mfma_f32_16x16x32_bf16 v[172:175], v[60:63], v[120:123], v[172:175]
    ds_write_b16_d16_hi v157, v76
    ds_write_b16 v158, v77
    ds_write_b16_d16_hi v159, v77
    s_waitcnt lgkmcnt(9)
    s_barrier
    v_mfma_f32_16x16x32_bf16 v[192:195], v[32:35], v[96:99], v[192:195]
    ds_read_b128 v[112:115], v2
    ds_read_b128 v[116:119], v20
    v_mfma_f32_16x16x32_bf16 v[208:211], v[32:35], v[100:103], v[208:211]
    ds_read_b128 v[120:123], v3
    ds_read_b128 v[124:127], v21
    v_mfma_f32_16x16x32_bf16 v[196:199], v[36:39], v[96:99], v[196:199]
    v_cvt_pk_bf16_f32 v80, v160, v161
    v_cvt_pk_bf16_f32 v81, v162, v163
    v_mul_f32 v164, s65, v164
    v_mfma_f32_16x16x32_bf16 v[212:215], v[36:39], v[100:103], v[212:215]
    v_mul_f32 v165, s65, v165
    v_mul_f32 v166, s65, v166
    v_mul_f32 v167, s65, v167
    v_mfma_f32_16x16x32_bf16 v[200:203], v[96:99], v[40:43], v[200:203]
    ds_write_b64 v11, v[80:81] offset:1024
    v_cvt_pk_bf16_f32 v84, v164, v165
    v_cvt_pk_bf16_f32 v85, v166, v167
    v_mfma_f32_16x16x32_bf16 v[216:219], v[100:103], v[40:43], v[216:219]
    v_cvt_pk_bf16_f32 v88, v168, v169
    v_cvt_pk_bf16_f32 v89, v170, v171
    ds_write_b64 v12, v[84:85] offset:1024
    v_mfma_f32_16x16x32_bf16 v[204:207], v[44:47], v[96:99], v[204:207]
    v_cvt_pk_bf16_f32 v82, v176, v177
    v_cvt_pk_bf16_f32 v83, v178, v179
    v_mul_f32 v180, s65, v180
    v_mfma_f32_16x16x32_bf16 v[192:195], v[48:51], v[104:107], v[192:195]
    v_mul_f32 v181, s65, v181
    v_mul_f32 v182, s65, v182
    v_mul_f32 v183, s65, v183
    v_mfma_f32_16x16x32_bf16 v[208:211], v[48:51], v[108:111], v[208:211]
    ds_write_b64 v11, v[82:83] offset:1088
    v_cvt_pk_bf16_f32 v86, v180, v181
    v_cvt_pk_bf16_f32 v87, v182, v183
    v_mfma_f32_16x16x32_bf16 v[196:199], v[52:55], v[104:107], v[196:199]
    v_cvt_pk_bf16_f32 v90, v184, v185
    v_cvt_pk_bf16_f32 v91, v186, v187
    ds_write_b64 v12, v[86:87] offset:1280
    v_mfma_f32_16x16x32_bf16 v[212:215], v[52:55], v[108:111], v[212:215]
    ds_write_b128 v13, v[88:91] offset:5824
    v_mul_f32 v172, v24, v172
    v_mul_f32 v173, v24, v173
    v_mfma_f32_16x16x32_bf16 v[200:203], v[104:107], v[56:59], v[200:203]
    v_mul_f32 v174, v24, v174
    v_mul_f32 v175, v24, v175
    v_cvt_pk_bf16_f32 v92, v172, v173
    v_mfma_f32_16x16x32_bf16 v[216:219], v[108:111], v[56:59], v[216:219]
    v_cvt_pk_bf16_f32 v93, v174, v175
    ds_write_b16 v188, v92
    ds_write_b16_d16_hi v189, v92
    v_mfma_f32_16x16x32_bf16 v[204:207], v[60:63], v[104:107], v[204:207]
    ds_write_b16 v190, v93
    ds_write_b16_d16_hi v191, v93
    s_waitcnt lgkmcnt(0)
    s_barrier
    v_mfma_f32_16x16x32_bf16 v[224:227], v[32:35], v[112:115], v[224:227]
    v_mfma_f32_16x16x32_bf16 v[240:243], v[32:35], v[116:119], v[240:243]
    v_cvt_pk_bf16_f32 v64, v192, v193
    v_cvt_pk_bf16_f32 v65, v194, v195
    v_mul_f32 v196, s65, v196
    v_mfma_f32_16x16x32_bf16 v[228:231], v[36:39], v[112:115], v[228:231]
    v_mul_f32 v197, s65, v197
    v_mul_f32 v198, s65, v198
    v_mul_f32 v199, s65, v199
    v_mfma_f32_16x16x32_bf16 v[244:247], v[36:39], v[116:119], v[244:247]
    ds_write_b64 v11, v[64:65] offset:9472
    v_cvt_pk_bf16_f32 v68, v196, v197
    v_cvt_pk_bf16_f32 v69, v198, v199
    v_mfma_f32_16x16x32_bf16 v[232:235], v[112:115], v[40:43], v[232:235]
    v_cvt_pk_bf16_f32 v72, v200, v201
    v_cvt_pk_bf16_f32 v73, v202, v203
    ds_write_b64 v12, v[68:69] offset:2048
    v_mfma_f32_16x16x32_bf16 v[248:251], v[116:119], v[40:43], v[248:251]
    v_cvt_pk_bf16_f32 v66, v208, v209
    v_cvt_pk_bf16_f32 v67, v210, v211
    v_mul_f32 v212, s65, v212
    v_mfma_f32_16x16x32_bf16 v[236:239], v[44:47], v[112:115], v[236:239]
    v_mul_f32 v213, s65, v213
    v_mul_f32 v214, s65, v214
    v_mul_f32 v215, s65, v215
    v_mfma_f32_16x16x32_bf16 v[224:227], v[48:51], v[120:123], v[224:227]
    ds_write_b64 v11, v[66:67] offset:9536
    v_cvt_pk_bf16_f32 v70, v212, v213
    v_cvt_pk_bf16_f32 v71, v214, v215
    v_mfma_f32_16x16x32_bf16 v[240:243], v[48:51], v[124:127], v[240:243]
    v_cvt_pk_bf16_f32 v74, v216, v217
    v_cvt_pk_bf16_f32 v75, v218, v219
    ds_write_b64 v12, v[70:71] offset:2304
    v_mfma_f32_16x16x32_bf16 v[228:231], v[52:55], v[120:123], v[228:231]
    ds_write_b128 v13, v[72:75] offset:14080
    v_mul_f32 v204, v24, v204
    v_mul_f32 v205, v24, v205
    v_mfma_f32_16x16x32_bf16 v[244:247], v[52:55], v[124:127], v[244:247]
    v_mul_f32 v206, v24, v206
    v_mul_f32 v207, v24, v207
    v_cvt_pk_bf16_f32 v76, v204, v205
    v_mfma_f32_16x16x32_bf16 v[232:235], v[120:123], v[56:59], v[232:235]
    v_cvt_pk_bf16_f32 v77, v206, v207
    ds_write_b16 v220, v76
    ds_write_b16_d16_hi v221, v76
    v_mfma_f32_16x16x32_bf16 v[248:251], v[124:127], v[56:59], v[248:251]
    ds_write_b16 v222, v77
    ds_write_b16_d16_hi v223, v77
    v_mfma_f32_16x16x32_bf16 v[236:239], v[60:63], v[120:123], v[236:239]
    s_nop 1
    v_cvt_pk_bf16_f32 v80, v224, v225
    v_cvt_pk_bf16_f32 v81, v226, v227
    v_mul_f32 v228, s65, v228
    v_mul_f32 v229, s65, v229
    v_mul_f32 v230, s65, v230
    v_mul_f32 v231, s65, v231
    ds_write_b64 v11, v[80:81] offset:10496
    v_cvt_pk_bf16_f32 v84, v228, v229
    v_cvt_pk_bf16_f32 v85, v230, v231
    v_cvt_pk_bf16_f32 v88, v232, v233
    v_cvt_pk_bf16_f32 v89, v234, v235
    ds_write_b64 v12, v[84:85] offset:3072
    v_cvt_pk_bf16_f32 v82, v240, v241
    v_cvt_pk_bf16_f32 v83, v242, v243
    v_mul_f32 v244, s65, v244
    v_mul_f32 v245, s65, v245
    v_mul_f32 v246, s65, v246
    v_mul_f32 v247, s65, v247
    ds_write_b64 v11, v[82:83] offset:10560
    v_cvt_pk_bf16_f32 v86, v244, v245
    v_cvt_pk_bf16_f32 v87, v246, v247
    v_cvt_pk_bf16_f32 v90, v248, v249
    v_cvt_pk_bf16_f32 v91, v250, v251
    ds_write_b64 v12, v[86:87] offset:3328
    ds_write_b128 v13, v[88:91] offset:15296
    v_mul_f32 v236, v24, v236
    v_mul_f32 v237, v24, v237
    v_mul_f32 v238, v24, v238
    v_mul_f32 v239, v24, v239
    v_cvt_pk_bf16_f32 v92, v236, v237
    v_cvt_pk_bf16_f32 v93, v238, v239
    ds_write_b16 v252, v92
    ds_write_b16_d16_hi v253, v92
    ds_write_b16 v254, v93
    ds_write_b16_d16_hi v255, v93
    v_mov_b32 v192, 0
    v_mov_b32 v193, 0
    v_mov_b32 v194, 0
    v_mov_b32 v195, 0
    v_mov_b32 v196, 0
    v_mov_b32 v197, 0
    v_mov_b32 v198, 0
    v_mov_b32 v199, 0
    v_mov_b32 v200, 0
    v_mov_b32 v201, 0
    v_mov_b32 v202, 0
    v_mov_b32 v208, 0
    v_mov_b32 v209, 0
    v_mov_b32 v210, 0
    v_mov_b32 v211, 0
    v_mov_b32 v212, 0
    v_mov_b32 v213, 0
    v_mov_b32 v214, 0
    v_mov_b32 v215, 0
    v_mov_b32 v216, 0
    v_mov_b32 v217, 0
    v_mov_b32 v218, 0
    v_mov_b32 v203, 0
    v_mov_b32 v204, 0
    v_mov_b32 v205, 0
    v_mov_b32 v206, 0
    v_mov_b32 v207, 0
    v_mov_b32 v219, 0
    v_mov_b32 v220, 0
    v_mov_b32 v221, 0
    v_mov_b32 v222, 0
    v_mov_b32 v223, 0
    s_waitcnt lgkmcnt(0)
    ds_read_b128 v[32:35], v23 offset:0
    ds_read_b128 v[36:39], v23 offset:1024
    v_add_u32 v23, s6, v23
    ds_read_b128 v[40:43], v23 offset:0
    ds_read_b128 v[44:47], v23 offset:1024
    s_barrier
    ds_read_b128 v[80:83], v6 offset:0
    ds_read2_b32 v[108:109], v19 offset0:0 offset1:2
    ds_read_b128 v[56:59], v7 offset:4096
    ds_read_b128 v[88:91], v8 offset:4608
    ds_read_b128 v[96:99], v8 offset:5216
    ds_read_b128 v[26:29], v25 offset:512
    v_mov_b32 v49, 0
    v_mov_b32 v50, 0
    v_mov_b32 v53, 0
    v_mov_b32 v54, 0
    v_mov_b32 v184, 0
    v_mov_b32 v185, 0
    v_mov_b32 v186, 0
    v_mov_b32 v187, 0
    v_mov_b32 v188, 0
    v_mov_b32 v189, 0
    v_mov_b32 v190, 0
    v_mov_b32 v191, 0
    v_mov_b32 v100, 0
    v_mov_b32 v101, 0
    v_mov_b32 v102, 0
    v_mov_b32 v103, 0
    s_mov_b32 s46, 0
    s_mov_b32 s62, 37888
    s_mov_b32 s63, 4294929408
    s_waitcnt lgkmcnt(4)
    v_mfma_f32_32x32x16_bf16 v[128:143], v[80:83], v[32:35], 0
    v_mov_b32 v48, v108
    v_mov_b32 v51, v108
    v_mov_b32 v52, v109
    v_mov_b32 v55, v109
    v_mfma_f32_32x32x16_bf16 v[144:159], v[80:83], v[36:39], 0
    v_mov_b32 v224, 0
    v_mov_b32 v225, 0
    v_mov_b32 v226, 0
    v_mov_b32 v227, 0
    v_mov_b32 v228, 0
    v_mfma_f32_32x32x16_bf16 v[160:175], v[80:83], v[40:43], 0
    v_mov_b32 v229, 0
    v_mov_b32 v230, 0
    v_mov_b32 v231, 0
    v_mov_b32 v232, 0
    v_mov_b32 v233, 0
    s_waitcnt lgkmcnt(3)
    v_mfma_f32_32x32x4_2b_bf16 v[128:159], v[56:57], v[48:49], v[128:159]
    v_mov_b32 v234, 0
    v_mov_b32 v240, 0
    v_mov_b32 v241, 0
    v_mov_b32 v242, 0
    v_mov_b32 v243, 0
    v_mov_b32 v244, 0
    v_mov_b32 v245, 0
    v_mov_b32 v246, 0
    v_mov_b32 v247, 0
    v_mov_b32 v248, 0
    v_mov_b32 v249, 0
    v_mov_b32 v250, 0
    v_mov_b32 v235, 0
    v_mov_b32 v236, 0
    v_mov_b32 v237, 0
    v_mov_b32 v238, 0
    v_mov_b32 v239, 0
    v_mov_b32 v251, 0
    v_mov_b32 v252, 0
    v_mov_b32 v253, 0
    v_mov_b32 v254, 0
    v_mov_b32 v255, 0
    s_waitcnt lgkmcnt(0)
    s_setprio 2
    .p2align 6
k_att:
    v_exp_f32 v128, v128
    v_exp_f32 v129, v129
    v_smfmac_f32_32x32x32_bf16 v[240:255], v[100:103], v[184:191], v10
    ds_read_b128 v[100:103], v8 offset:6432
    v_exp_f32 v130, v130
    v_exp_f32 v131, v131
    v_exp_f32 v132, v132
    v_mfma_f32_32x32x16_bf16 v[176:191], v[80:83], v[44:47], 0
    ds_read_b128 v[84:87], v6 offset:1024
    v_exp_f32 v133, v133
    v_exp_f32 v134, v134
    v_exp_f32 v135, v135
    v_exp_f32 v136, v136
    v_exp_f32 v137, v137
    v_smfmac_f32_32x32x32_bf16 v[192:207], v[88:91], v[128:135], v10
    ds_read_b128 v[92:95], v8 offset:5824
    v_exp_f32 v138, v138
    v_exp_f32 v139, v139
    v_exp_f32 v140, v140
    v_exp_f32 v141, v141
    v_mfma_f32_32x32x4_2b_bf16 v[160:191], v[56:57], v[52:53], v[160:191]
    v_exp_f32 v142, v142
    v_exp_f32 v143, v143
    v_exp_f32 v144, v144
    v_exp_f32 v145, v145
    v_exp_f32 v146, v146
    v_exp_f32 v147, v147
    v_exp_f32 v148, v148
    v_exp_f32 v149, v149
    v_smfmac_f32_32x32x32_bf16 v[192:207], v[96:99], v[136:143], v10
    v_exp_f32 v150, v150
    v_exp_f32 v151, v151
    v_exp_f32 v152, v152
    v_exp_f32 v153, v153
    v_smfmac_f32_32x32x32_bf16 v[208:223], v[88:91], v[144:151], v10
    s_waitcnt lgkmcnt(0)
    v_exp_f32 v154, v154
    v_exp_f32 v155, v155
    v_exp_f32 v156, v156
    v_exp_f32 v157, v157
    v_mfma_f32_32x32x16_bf16 v[128:143], v[84:87], v[32:35], 0
    v_exp_f32 v158, v158
    v_exp_f32 v159, v159
    v_exp_f32 v160, v160
    v_exp_f32 v161, v161
    v_smfmac_f32_32x32x32_bf16 v[208:223], v[96:99], v[152:159], v10
    v_exp_f32 v162, v162
    v_exp_f32 v163, v163
    v_exp_f32 v164, v164
    v_mfma_f32_32x32x16_bf16 v[144:159], v[84:87], v[36:39], 0
    v_exp_f32 v165, v165
    v_exp_f32 v166, v166
    v_exp_f32 v167, v167
    v_exp_f32 v168, v168
    v_exp_f32 v169, v169
    v_smfmac_f32_32x32x32_bf16 v[224:239], v[88:91], v[160:167], v10
    v_exp_f32 v170, v170
    v_exp_f32 v171, v171
    v_exp_f32 v172, v172
    v_exp_f32 v173, v173
    v_mfma_f32_32x32x4_2b_bf16 v[128:159], v[56:57], v[50:51], v[128:159]
    v_exp_f32 v174, v174
    v_exp_f32 v175, v175
    v_exp_f32 v176, v176
    v_exp_f32 v177, v177
    v_exp_f32 v178, v178
    v_exp_f32 v179, v179
    v_exp_f32 v180, v180
    v_exp_f32 v181, v181
    v_smfmac_f32_32x32x32_bf16 v[224:239], v[96:99], v[168:175], v10
    v_exp_f32 v182, v182
    v_exp_f32 v183, v183
    v_exp_f32 v184, v184
    v_exp_f32 v185, v185
    v_smfmac_f32_32x32x32_bf16 v[240:255], v[88:91], v[176:183], v10
    v_exp_f32 v186, v186
    v_exp_f32 v187, v187
    v_exp_f32 v188, v188
    v_exp_f32 v189, v189
    v_mfma_f32_32x32x16_bf16 v[160:175], v[84:87], v[40:43], 0
    v_exp_f32 v190, v190
    v_exp_f32 v191, v191
    v_exp_f32 v128, v128
    v_exp_f32 v129, v129
    v_smfmac_f32_32x32x32_bf16 v[240:255], v[96:99], v[184:191], v10
    ds_read_b128 v[96:99], v8 offset:7648
    v_exp_f32 v130, v130
    v_exp_f32 v131, v131
    v_exp_f32 v132, v132
    v_mfma_f32_32x32x16_bf16 v[176:191], v[84:87], v[44:47], 0
    ds_read_b128 v[80:83], v6 offset:2048
    v_exp_f32 v133, v133
    v_exp_f32 v134, v134
    v_exp_f32 v135, v135
    v_exp_f32 v136, v136
    v_exp_f32 v137, v137
    v_smfmac_f32_32x32x32_bf16 v[192:207], v[92:95], v[128:135], v10
    ds_read_b128 v[88:91], v8 offset:7040
    v_exp_f32 v138, v138
    v_exp_f32 v139, v139
    v_exp_f32 v140, v140
    v_exp_f32 v141, v141
    v_mfma_f32_32x32x4_2b_bf16 v[160:191], v[56:57], v[54:55], v[160:191]
    v_exp_f32 v142, v142
    v_exp_f32 v143, v143
    v_exp_f32 v144, v144
    v_exp_f32 v145, v145
    v_exp_f32 v146, v146
    v_exp_f32 v147, v147
    v_exp_f32 v148, v148
    v_exp_f32 v149, v149
    v_smfmac_f32_32x32x32_bf16 v[192:207], v[100:103], v[136:143], v10
    v_exp_f32 v150, v150
    v_exp_f32 v151, v151
    v_exp_f32 v152, v152
    v_exp_f32 v153, v153
    v_smfmac_f32_32x32x32_bf16 v[208:223], v[92:95], v[144:151], v10
    s_waitcnt lgkmcnt(0)
    v_exp_f32 v154, v154
    v_exp_f32 v155, v155
    v_exp_f32 v156, v156
    v_exp_f32 v157, v157
    v_mfma_f32_32x32x16_bf16 v[128:143], v[80:83], v[32:35], 0
    v_exp_f32 v158, v158
    v_exp_f32 v159, v159
    v_exp_f32 v160, v160
    v_exp_f32 v161, v161
    v_smfmac_f32_32x32x32_bf16 v[208:223], v[100:103], v[152:159], v10
    v_exp_f32 v162, v162
    v_exp_f32 v163, v163
    v_exp_f32 v164, v164
    v_mfma_f32_32x32x16_bf16 v[144:159], v[80:83], v[36:39], 0
    v_exp_f32 v165, v165
    v_exp_f32 v166, v166
    v_exp_f32 v167, v167
    v_exp_f32 v168, v168
    v_exp_f32 v169, v169
    v_smfmac_f32_32x32x32_bf16 v[224:239], v[92:95], v[160:167], v10
    v_exp_f32 v170, v170
    v_exp_f32 v171, v171
    v_exp_f32 v172, v172
    v_exp_f32 v173, v173
    v_mfma_f32_32x32x4_2b_bf16 v[128:159], v[58:59], v[48:49], v[128:159]
    v_exp_f32 v174, v174
    v_exp_f32 v175, v175
    v_exp_f32 v176, v176
    v_exp_f32 v177, v177
    v_exp_f32 v178, v178
    v_exp_f32 v179, v179
    v_exp_f32 v180, v180
    v_exp_f32 v181, v181
    v_smfmac_f32_32x32x32_bf16 v[224:239], v[100:103], v[168:175], v10
    v_exp_f32 v182, v182
    v_exp_f32 v183, v183
    v_exp_f32 v184, v184
    v_exp_f32 v185, v185
    v_smfmac_f32_32x32x32_bf16 v[240:255], v[92:95], v[176:183], v10
    v_exp_f32 v186, v186
    v_exp_f32 v187, v187
    v_exp_f32 v188, v188
    v_exp_f32 v189, v189
    v_mfma_f32_32x32x16_bf16 v[160:175], v[80:83], v[40:43], 0
    v_exp_f32 v190, v190
    v_exp_f32 v191, v191
    v_exp_f32 v128, v128
    v_exp_f32 v129, v129
    v_smfmac_f32_32x32x32_bf16 v[240:255], v[100:103], v[184:191], v10
    ds_read_b128 v[100:103], v8 offset:8864
    v_exp_f32 v130, v130
    v_exp_f32 v131, v131
    v_exp_f32 v132, v132
    v_mfma_f32_32x32x16_bf16 v[176:191], v[80:83], v[44:47], 0
    ds_read_b128 v[84:87], v6 offset:3072
    v_exp_f32 v133, v133
    v_exp_f32 v134, v134
    v_exp_f32 v135, v135
    v_exp_f32 v136, v136
    v_exp_f32 v137, v137
    v_smfmac_f32_32x32x32_bf16 v[192:207], v[88:91], v[128:135], v10
    ds_read_b128 v[92:95], v8 offset:8256
    v_exp_f32 v138, v138
    v_exp_f32 v139, v139
    v_exp_f32 v140, v140
    v_exp_f32 v141, v141
    v_mfma_f32_32x32x4_2b_bf16 v[160:191], v[58:59], v[52:53], v[160:191]
    v_exp_f32 v142, v142
    v_exp_f32 v143, v143
    v_exp_f32 v144, v144
    v_exp_f32 v145, v145
    v_exp_f32 v146, v146
    v_exp_f32 v147, v147
    v_exp_f32 v148, v148
    v_exp_f32 v149, v149
    v_smfmac_f32_32x32x32_bf16 v[192:207], v[96:99], v[136:143], v10
    v_exp_f32 v150, v150
    v_exp_f32 v151, v151
    v_exp_f32 v152, v152
    v_exp_f32 v153, v153
    v_smfmac_f32_32x32x32_bf16 v[208:223], v[88:91], v[144:151], v10
    s_waitcnt lgkmcnt(0)
    v_exp_f32 v154, v154
    v_exp_f32 v155, v155
    v_exp_f32 v156, v156
    v_exp_f32 v157, v157
    v_mfma_f32_32x32x16_bf16 v[128:143], v[84:87], v[32:35], 0
    v_exp_f32 v158, v158
    v_exp_f32 v159, v159
    v_exp_f32 v160, v160
    v_exp_f32 v161, v161
    v_smfmac_f32_32x32x32_bf16 v[208:223], v[96:99], v[152:159], v10
    v_exp_f32 v162, v162
    v_exp_f32 v163, v163
    v_exp_f32 v164, v164
    v_mfma_f32_32x32x16_bf16 v[144:159], v[84:87], v[36:39], 0
    v_exp_f32 v165, v165
    v_exp_f32 v166, v166
    v_exp_f32 v167, v167
    v_exp_f32 v168, v168
    v_exp_f32 v169, v169
    v_smfmac_f32_32x32x32_bf16 v[224:239], v[88:91], v[160:167], v10
    v_exp_f32 v170, v170
    v_exp_f32 v171, v171
    v_exp_f32 v172, v172
    v_exp_f32 v173, v173
    v_mfma_f32_32x32x4_2b_bf16 v[128:159], v[58:59], v[50:51], v[128:159]
    v_exp_f32 v174, v174
    v_exp_f32 v175, v175
    v_exp_f32 v176, v176
    v_exp_f32 v177, v177
    v_exp_f32 v178, v178
    v_exp_f32 v179, v179
    v_exp_f32 v180, v180
    v_exp_f32 v181, v181
    v_smfmac_f32_32x32x32_bf16 v[224:239], v[96:99], v[168:175], v10
    v_exp_f32 v182, v182
    v_exp_f32 v183, v183
    v_exp_f32 v184, v184
    v_exp_f32 v185, v185
    v_smfmac_f32_32x32x32_bf16 v[240:255], v[88:91], v[176:183], v10
    v_exp_f32 v186, v186
    v_exp_f32 v187, v187
    v_exp_f32 v188, v188
    v_exp_f32 v189, v189
    v_mfma_f32_32x32x16_bf16 v[160:175], v[84:87], v[40:43], 0
    v_exp_f32 v190, v190
    v_exp_f32 v191, v191
    v_exp_f32 v128, v128
    v_exp_f32 v129, v129
    v_smfmac_f32_32x32x32_bf16 v[240:255], v[96:99], v[184:191], v10
    ds_read_b128 v[96:99], v8 offset:14688
    v_exp_f32 v130, v130
    v_exp_f32 v131, v131
    v_exp_f32 v132, v132
    v_mfma_f32_32x32x16_bf16 v[176:191], v[84:87], v[44:47], 0
    ds_read_b128 v[80:83], v6 offset:9472
    v_exp_f32 v133, v133
    v_exp_f32 v134, v134
    v_exp_f32 v135, v135
    v_exp_f32 v136, v136
    v_exp_f32 v137, v137
    v_smfmac_f32_32x32x32_bf16 v[192:207], v[92:95], v[128:135], v10
    ds_read_b128 v[88:91], v8 offset:14080
    v_exp_f32 v138, v138
    v_exp_f32 v139, v139
    v_exp_f32 v140, v140
    v_exp_f32 v141, v141
    v_mfma_f32_32x32x4_2b_bf16 v[160:191], v[58:59], v[54:55], v[160:191]
    ds_read_b128 v[60:63], v7 offset:13568
    v_exp_f32 v142, v142
    v_exp_f32 v143, v143
    v_exp_f32 v144, v144
    v_exp_f32 v145, v145
    v_exp_f32 v146, v146
    v_exp_f32 v147, v147
    v_exp_f32 v148, v148
    v_exp_f32 v149, v149
    v_smfmac_f32_32x32x32_bf16 v[192:207], v[100:103], v[136:143], v10
    v_exp_f32 v150, v150
    v_exp_f32 v151, v151
    v_exp_f32 v152, v152
    v_exp_f32 v153, v153
    v_smfmac_f32_32x32x32_bf16 v[208:223], v[92:95], v[144:151], v10
    s_waitcnt lgkmcnt(0)
    v_exp_f32 v154, v154
    v_exp_f32 v155, v155
    v_exp_f32 v156, v156
    v_exp_f32 v157, v157
    v_mfma_f32_32x32x16_bf16 v[128:143], v[80:83], v[32:35], 0
    v_exp_f32 v158, v158
    v_exp_f32 v159, v159
    v_exp_f32 v160, v160
    v_exp_f32 v161, v161
    v_smfmac_f32_32x32x32_bf16 v[208:223], v[100:103], v[152:159], v10
    v_exp_f32 v162, v162
    v_exp_f32 v163, v163
    v_exp_f32 v164, v164
    v_mfma_f32_32x32x16_bf16 v[144:159], v[80:83], v[36:39], 0
    v_exp_f32 v165, v165
    v_exp_f32 v166, v166
    v_exp_f32 v167, v167
    v_exp_f32 v168, v168
    v_exp_f32 v169, v169
    v_smfmac_f32_32x32x32_bf16 v[224:239], v[92:95], v[160:167], v10
    v_exp_f32 v170, v170
    v_exp_f32 v171, v171
    v_exp_f32 v172, v172
    v_exp_f32 v173, v173
    v_mfma_f32_32x32x4_2b_bf16 v[128:159], v[60:61], v[48:49], v[128:159]
    v_exp_f32 v174, v174
    v_exp_f32 v175, v175
    v_exp_f32 v176, v176
    v_exp_f32 v177, v177
    v_exp_f32 v178, v178
    v_exp_f32 v179, v179
    v_exp_f32 v180, v180
    v_exp_f32 v181, v181
    v_smfmac_f32_32x32x32_bf16 v[224:239], v[100:103], v[168:175], v10
    v_exp_f32 v182, v182
    v_exp_f32 v183, v183
    v_exp_f32 v184, v184
    v_exp_f32 v185, v185
    v_smfmac_f32_32x32x32_bf16 v[240:255], v[92:95], v[176:183], v10
    v_exp_f32 v186, v186
    v_exp_f32 v187, v187
    v_exp_f32 v188, v188
    v_exp_f32 v189, v189
    v_mfma_f32_32x32x16_bf16 v[160:175], v[80:83], v[40:43], 0
    v_exp_f32 v190, v190
    v_exp_f32 v191, v191
    v_exp_f32 v128, v128
    v_exp_f32 v129, v129
    v_smfmac_f32_32x32x32_bf16 v[240:255], v[100:103], v[184:191], v10
    ds_read_b128 v[100:103], v8 offset:15904
    v_exp_f32 v130, v130
    v_exp_f32 v131, v131
    v_exp_f32 v132, v132
    v_mfma_f32_32x32x16_bf16 v[176:191], v[80:83], v[44:47], 0
    ds_read_b128 v[84:87], v6 offset:10496
    v_exp_f32 v133, v133
    v_exp_f32 v134, v134
    v_exp_f32 v135, v135
    v_exp_f32 v136, v136
    v_exp_f32 v137, v137
    v_smfmac_f32_32x32x32_bf16 v[192:207], v[88:91], v[128:135], v10
    ds_read_b128 v[92:95], v8 offset:15296
    v_exp_f32 v138, v138
    v_exp_f32 v139, v139
    v_exp_f32 v140, v140
    v_exp_f32 v141, v141
    v_mfma_f32_32x32x4_2b_bf16 v[160:191], v[60:61], v[52:53], v[160:191]
    v_exp_f32 v142, v142
    v_exp_f32 v143, v143
    v_exp_f32 v144, v144
    v_exp_f32 v145, v145
    v_exp_f32 v146, v146
    v_exp_f32 v147, v147
    v_exp_f32 v148, v148
    v_exp_f32 v149, v149
    v_smfmac_f32_32x32x32_bf16 v[192:207], v[96:99], v[136:143], v10
    v_exp_f32 v150, v150
    v_exp_f32 v151, v151
    v_exp_f32 v152, v152
    v_exp_f32 v153, v153
    v_smfmac_f32_32x32x32_bf16 v[208:223], v[88:91], v[144:151], v10
    s_waitcnt lgkmcnt(0)
    v_exp_f32 v154, v154
    v_exp_f32 v155, v155
    v_exp_f32 v156, v156
    v_exp_f32 v157, v157
    v_mfma_f32_32x32x16_bf16 v[128:143], v[84:87], v[32:35], 0
    v_exp_f32 v158, v158
    v_exp_f32 v159, v159
    v_exp_f32 v160, v160
    v_exp_f32 v161, v161
    v_smfmac_f32_32x32x32_bf16 v[208:223], v[96:99], v[152:159], v10
    v_exp_f32 v162, v162
    v_exp_f32 v163, v163
    v_exp_f32 v164, v164
    v_mfma_f32_32x32x16_bf16 v[144:159], v[84:87], v[36:39], 0
    v_exp_f32 v165, v165
    v_exp_f32 v166, v166
    v_exp_f32 v167, v167
    v_exp_f32 v168, v168
    v_exp_f32 v169, v169
    v_smfmac_f32_32x32x32_bf16 v[224:239], v[88:91], v[160:167], v10
    v_exp_f32 v170, v170
    v_exp_f32 v171, v171
    v_exp_f32 v172, v172
    v_exp_f32 v173, v173
    v_mfma_f32_32x32x4_2b_bf16 v[128:159], v[60:61], v[50:51], v[128:159]
    v_exp_f32 v174, v174
    v_exp_f32 v175, v175
    v_exp_f32 v176, v176
    v_exp_f32 v177, v177
    v_exp_f32 v178, v178
    v_exp_f32 v179, v179
    v_exp_f32 v180, v180
    v_exp_f32 v181, v181
    v_smfmac_f32_32x32x32_bf16 v[224:239], v[96:99], v[168:175], v10
    v_exp_f32 v182, v182
    v_exp_f32 v183, v183
    v_exp_f32 v184, v184
    v_exp_f32 v185, v185
    v_smfmac_f32_32x32x32_bf16 v[240:255], v[88:91], v[176:183], v10
    v_exp_f32 v186, v186
    v_exp_f32 v187, v187
    v_exp_f32 v188, v188
    v_exp_f32 v189, v189
    v_mfma_f32_32x32x16_bf16 v[160:175], v[84:87], v[40:43], 0
    v_exp_f32 v190, v190
    v_exp_f32 v191, v191
    v_exp_f32 v128, v128
    v_exp_f32 v129, v129
    v_smfmac_f32_32x32x32_bf16 v[240:255], v[96:99], v[184:191], v10
    ds_read_b128 v[96:99], v8 offset:17120
    v_exp_f32 v130, v130
    v_exp_f32 v131, v131
    v_exp_f32 v132, v132
    v_mfma_f32_32x32x16_bf16 v[176:191], v[84:87], v[44:47], 0
    ds_read_b128 v[80:83], v6 offset:11520
    v_exp_f32 v133, v133
    v_exp_f32 v134, v134
    v_exp_f32 v135, v135
    v_exp_f32 v136, v136
    v_exp_f32 v137, v137
    v_smfmac_f32_32x32x32_bf16 v[192:207], v[92:95], v[128:135], v10
    ds_read_b128 v[88:91], v8 offset:16512
    v_exp_f32 v138, v138
    v_exp_f32 v139, v139
    v_exp_f32 v140, v140
    v_exp_f32 v141, v141
    v_mfma_f32_32x32x4_2b_bf16 v[160:191], v[60:61], v[54:55], v[160:191]
    v_exp_f32 v142, v142
    v_exp_f32 v143, v143
    v_exp_f32 v144, v144
    v_exp_f32 v145, v145
    v_exp_f32 v146, v146
    v_exp_f32 v147, v147
    v_exp_f32 v148, v148
    v_exp_f32 v149, v149
    v_smfmac_f32_32x32x32_bf16 v[192:207], v[100:103], v[136:143], v10
    v_exp_f32 v150, v150
    v_exp_f32 v151, v151
    v_exp_f32 v152, v152
    v_exp_f32 v153, v153
    v_smfmac_f32_32x32x32_bf16 v[208:223], v[92:95], v[144:151], v10
    s_waitcnt lgkmcnt(0)
    v_exp_f32 v154, v154
    v_exp_f32 v155, v155
    v_exp_f32 v156, v156
    v_exp_f32 v157, v157
    v_mfma_f32_32x32x16_bf16 v[128:143], v[80:83], v[32:35], 0
    v_exp_f32 v158, v158
    v_exp_f32 v159, v159
    v_exp_f32 v160, v160
    v_exp_f32 v161, v161
    v_smfmac_f32_32x32x32_bf16 v[208:223], v[100:103], v[152:159], v10
    v_exp_f32 v162, v162
    v_exp_f32 v163, v163
    v_exp_f32 v164, v164
    v_mfma_f32_32x32x16_bf16 v[144:159], v[80:83], v[36:39], 0
    v_exp_f32 v165, v165
    v_exp_f32 v166, v166
    v_exp_f32 v167, v167
    v_exp_f32 v168, v168
    v_exp_f32 v169, v169
    v_smfmac_f32_32x32x32_bf16 v[224:239], v[92:95], v[160:167], v10
    v_exp_f32 v170, v170
    v_exp_f32 v171, v171
    v_exp_f32 v172, v172
    v_exp_f32 v173, v173
    v_mfma_f32_32x32x4_2b_bf16 v[128:159], v[62:63], v[48:49], v[128:159]
    v_exp_f32 v174, v174
    v_exp_f32 v175, v175
    v_exp_f32 v176, v176
    v_exp_f32 v177, v177
    v_exp_f32 v178, v178
    v_exp_f32 v179, v179
    v_exp_f32 v180, v180
    v_exp_f32 v181, v181
    v_smfmac_f32_32x32x32_bf16 v[224:239], v[100:103], v[168:175], v10
    v_exp_f32 v182, v182
    v_exp_f32 v183, v183
    v_exp_f32 v184, v184
    v_exp_f32 v185, v185
    v_smfmac_f32_32x32x32_bf16 v[240:255], v[92:95], v[176:183], v10
    v_exp_f32 v186, v186
    v_exp_f32 v187, v187
    v_exp_f32 v188, v188
    v_exp_f32 v189, v189
    v_mfma_f32_32x32x16_bf16 v[160:175], v[80:83], v[40:43], 0
    v_exp_f32 v190, v190
    v_exp_f32 v191, v191
    v_exp_f32 v128, v128
    v_exp_f32 v129, v129
    v_smfmac_f32_32x32x32_bf16 v[240:255], v[100:103], v[184:191], v10
    ds_read_b128 v[100:103], v8 offset:18336
    v_exp_f32 v130, v130
    v_exp_f32 v131, v131
    v_exp_f32 v132, v132
    v_mfma_f32_32x32x16_bf16 v[176:191], v[80:83], v[44:47], 0
    ds_read_b128 v[84:87], v6 offset:12544
    v_exp_f32 v133, v133
    v_exp_f32 v134, v134
    v_exp_f32 v135, v135
    v_exp_f32 v136, v136
    v_exp_f32 v137, v137
    v_smfmac_f32_32x32x32_bf16 v[192:207], v[88:91], v[128:135], v10
    ds_read_b128 v[92:95], v8 offset:17728
    v_exp_f32 v138, v138
    v_exp_f32 v139, v139
    v_exp_f32 v140, v140
    v_exp_f32 v141, v141
    v_mfma_f32_32x32x4_2b_bf16 v[160:191], v[62:63], v[52:53], v[160:191]
    v_exp_f32 v142, v142
    v_exp_f32 v143, v143
    v_exp_f32 v144, v144
    v_exp_f32 v145, v145
    v_exp_f32 v146, v146
    v_exp_f32 v147, v147
    v_exp_f32 v148, v148
    v_exp_f32 v149, v149
    v_smfmac_f32_32x32x32_bf16 v[192:207], v[96:99], v[136:143], v10
    v_exp_f32 v150, v150
    v_exp_f32 v151, v151
    v_exp_f32 v152, v152
    v_exp_f32 v153, v153
    v_smfmac_f32_32x32x32_bf16 v[208:223], v[88:91], v[144:151], v10
    s_waitcnt lgkmcnt(0)
    v_exp_f32 v154, v154
    v_exp_f32 v155, v155
    v_exp_f32 v156, v156
    v_exp_f32 v157, v157
    v_mfma_f32_32x32x16_bf16 v[128:143], v[84:87], v[32:35], 0
    v_exp_f32 v158, v158
    v_exp_f32 v159, v159
    v_exp_f32 v160, v160
    v_exp_f32 v161, v161
    v_smfmac_f32_32x32x32_bf16 v[208:223], v[96:99], v[152:159], v10
    v_exp_f32 v162, v162
    v_exp_f32 v163, v163
    v_exp_f32 v164, v164
    v_mfma_f32_32x32x16_bf16 v[144:159], v[84:87], v[36:39], 0
    v_exp_f32 v165, v165
    v_exp_f32 v166, v166
    v_exp_f32 v167, v167
    v_exp_f32 v168, v168
    v_exp_f32 v169, v169
    v_smfmac_f32_32x32x32_bf16 v[224:239], v[88:91], v[160:167], v10
    v_exp_f32 v170, v170
    v_exp_f32 v171, v171
    v_exp_f32 v172, v172
    v_exp_f32 v173, v173
    v_mfma_f32_32x32x4_2b_bf16 v[128:159], v[62:63], v[50:51], v[128:159]
    v_exp_f32 v174, v174
    v_exp_f32 v175, v175
    v_exp_f32 v176, v176
    v_exp_f32 v177, v177
    v_exp_f32 v178, v178
    v_exp_f32 v179, v179
    v_exp_f32 v180, v180
    v_exp_f32 v181, v181
    v_smfmac_f32_32x32x32_bf16 v[224:239], v[96:99], v[168:175], v10
    v_exp_f32 v182, v182
    v_exp_f32 v183, v183
    v_exp_f32 v184, v184
    v_exp_f32 v185, v185
    v_smfmac_f32_32x32x32_bf16 v[240:255], v[88:91], v[176:183], v10
    v_exp_f32 v186, v186
    v_exp_f32 v187, v187
    v_exp_f32 v188, v188
    v_exp_f32 v189, v189
    v_mfma_f32_32x32x16_bf16 v[160:175], v[84:87], v[40:43], 0
    s_bitcmp1_b32 9, s46
    s_cbranch_scc1 k_hook1
k_hook_ret1:
    v_exp_f32 v190, v190
    v_exp_f32 v191, v191
    v_exp_f32 v128, v128
    v_exp_f32 v129, v129
    v_smfmac_f32_32x32x32_bf16 v[240:255], v[96:99], v[184:191], v10
    ds_read_b128 v[96:99], v8 offset:24160
    v_exp_f32 v130, v130
    v_exp_f32 v131, v131
    v_exp_f32 v132, v132
    v_mfma_f32_32x32x16_bf16 v[176:191], v[84:87], v[44:47], 0
    ds_read_b128 v[80:83], v6 offset:18944
    v_exp_f32 v133, v133
    v_exp_f32 v134, v134
    v_exp_f32 v135, v135
    v_exp_f32 v136, v136
    v_exp_f32 v137, v137
    v_smfmac_f32_32x32x32_bf16 v[192:207], v[92:95], v[128:135], v10
    ds_read_b128 v[88:91], v8 offset:23552
    v_exp_f32 v138, v138
    v_exp_f32 v139, v139
    v_exp_f32 v140, v140
    v_exp_f32 v141, v141
    v_mfma_f32_32x32x4_2b_bf16 v[160:191], v[62:63], v[54:55], v[160:191]
    ds_read_b128 v[56:59], v7 offset:23040
    v_exp_f32 v142, v142
    v_exp_f32 v143, v143
    v_exp_f32 v144, v144
    v_exp_f32 v145, v145
    v_exp_f32 v146, v146
    v_exp_f32 v147, v147
    v_exp_f32 v148, v148
    v_exp_f32 v149, v149
    v_smfmac_f32_32x32x32_bf16 v[192:207], v[100:103], v[136:143], v10
    v_exp_f32 v150, v150
    v_exp_f32 v151, v151
    v_exp_f32 v152, v152
    v_exp_f32 v153, v153
    v_smfmac_f32_32x32x32_bf16 v[208:223], v[92:95], v[144:151], v10
    s_waitcnt lgkmcnt(0)
    v_exp_f32 v154, v154
    v_exp_f32 v155, v155
    v_exp_f32 v156, v156
    v_exp_f32 v157, v157
    v_mfma_f32_32x32x16_bf16 v[128:143], v[80:83], v[32:35], 0
    v_exp_f32 v158, v158
    v_exp_f32 v159, v159
    v_exp_f32 v160, v160
    v_exp_f32 v161, v161
    v_smfmac_f32_32x32x32_bf16 v[208:223], v[100:103], v[152:159], v10
    v_exp_f32 v162, v162
    v_exp_f32 v163, v163
    v_exp_f32 v164, v164
    v_mfma_f32_32x32x16_bf16 v[144:159], v[80:83], v[36:39], 0
    v_exp_f32 v165, v165
    v_exp_f32 v166, v166
    v_exp_f32 v167, v167
    v_exp_f32 v168, v168
    v_exp_f32 v169, v169
    v_smfmac_f32_32x32x32_bf16 v[224:239], v[92:95], v[160:167], v10
    v_exp_f32 v170, v170
    v_exp_f32 v171, v171
    v_exp_f32 v172, v172
    v_exp_f32 v173, v173
    v_mfma_f32_32x32x4_2b_bf16 v[128:159], v[56:57], v[48:49], v[128:159]
    v_exp_f32 v174, v174
    v_exp_f32 v175, v175
    v_exp_f32 v176, v176
    v_exp_f32 v177, v177
    v_exp_f32 v178, v178
    v_exp_f32 v179, v179
    v_exp_f32 v180, v180
    v_exp_f32 v181, v181
    v_smfmac_f32_32x32x32_bf16 v[224:239], v[100:103], v[168:175], v10
    v_exp_f32 v182, v182
    v_exp_f32 v183, v183
    v_exp_f32 v184, v184
    v_exp_f32 v185, v185
    v_smfmac_f32_32x32x32_bf16 v[240:255], v[92:95], v[176:183], v10
    v_exp_f32 v186, v186
    v_exp_f32 v187, v187
    v_exp_f32 v188, v188
    v_exp_f32 v189, v189
    v_mfma_f32_32x32x16_bf16 v[160:175], v[80:83], v[40:43], 0
    v_exp_f32 v190, v190
    v_exp_f32 v191, v191
    v_exp_f32 v128, v128
    v_exp_f32 v129, v129
    v_smfmac_f32_32x32x32_bf16 v[240:255], v[100:103], v[184:191], v10
    ds_read_b128 v[100:103], v8 offset:25376
    v_exp_f32 v130, v130
    v_exp_f32 v131, v131
    v_exp_f32 v132, v132
    v_mfma_f32_32x32x16_bf16 v[176:191], v[80:83], v[44:47], 0
    ds_read_b128 v[84:87], v6 offset:19968
    v_exp_f32 v133, v133
    v_exp_f32 v134, v134
    v_exp_f32 v135, v135
    v_exp_f32 v136, v136
    v_exp_f32 v137, v137
    v_smfmac_f32_32x32x32_bf16 v[192:207], v[88:91], v[128:135], v10
    ds_read_b128 v[92:95], v8 offset:24768
    v_exp_f32 v138, v138
    v_exp_f32 v139, v139
    v_exp_f32 v140, v140
    v_exp_f32 v141, v141
    v_mfma_f32_32x32x4_2b_bf16 v[160:191], v[56:57], v[52:53], v[160:191]
    v_exp_f32 v142, v142
    v_exp_f32 v143, v143
    v_exp_f32 v144, v144
    v_exp_f32 v145, v145
    v_exp_f32 v146, v146
    v_exp_f32 v147, v147
    v_exp_f32 v148, v148
    v_exp_f32 v149, v149
    v_smfmac_f32_32x32x32_bf16 v[192:207], v[96:99], v[136:143], v10
    v_exp_f32 v150, v150
    v_exp_f32 v151, v151
    v_exp_f32 v152, v152
    v_exp_f32 v153, v153
    v_smfmac_f32_32x32x32_bf16 v[208:223], v[88:91], v[144:151], v10
    s_waitcnt lgkmcnt(0)
    v_exp_f32 v154, v154
    v_exp_f32 v155, v155
    v_exp_f32 v156, v156
    v_exp_f32 v157, v157
    v_mfma_f32_32x32x16_bf16 v[128:143], v[84:87], v[32:35], 0
    v_exp_f32 v158, v158
    v_exp_f32 v159, v159
    v_exp_f32 v160, v160
    v_exp_f32 v161, v161
    v_smfmac_f32_32x32x32_bf16 v[208:223], v[96:99], v[152:159], v10
    v_exp_f32 v162, v162
    v_exp_f32 v163, v163
    v_exp_f32 v164, v164
    v_mfma_f32_32x32x16_bf16 v[144:159], v[84:87], v[36:39], 0
    v_exp_f32 v165, v165
    v_exp_f32 v166, v166
    v_exp_f32 v167, v167
    v_exp_f32 v168, v168
    v_exp_f32 v169, v169
    v_smfmac_f32_32x32x32_bf16 v[224:239], v[88:91], v[160:167], v10
    v_exp_f32 v170, v170
    v_exp_f32 v171, v171
    v_exp_f32 v172, v172
    v_exp_f32 v173, v173
    v_mfma_f32_32x32x4_2b_bf16 v[128:159], v[56:57], v[50:51], v[128:159]
    v_exp_f32 v174, v174
    v_exp_f32 v175, v175
    v_exp_f32 v176, v176
    v_exp_f32 v177, v177
    v_exp_f32 v178, v178
    v_exp_f32 v179, v179
    v_exp_f32 v180, v180
    v_exp_f32 v181, v181
    v_smfmac_f32_32x32x32_bf16 v[224:239], v[96:99], v[168:175], v10
    v_exp_f32 v182, v182
    v_exp_f32 v183, v183
    v_exp_f32 v184, v184
    v_exp_f32 v185, v185
    v_smfmac_f32_32x32x32_bf16 v[240:255], v[88:91], v[176:183], v10
    v_exp_f32 v186, v186
    v_exp_f32 v187, v187
    v_exp_f32 v188, v188
    v_exp_f32 v189, v189
    v_mfma_f32_32x32x16_bf16 v[160:175], v[84:87], v[40:43], 0
    v_exp_f32 v190, v190
    v_exp_f32 v191, v191
    v_exp_f32 v128, v128
    v_exp_f32 v129, v129
    v_smfmac_f32_32x32x32_bf16 v[240:255], v[96:99], v[184:191], v10
    ds_read_b128 v[96:99], v8 offset:26592
    v_exp_f32 v130, v130
    v_exp_f32 v131, v131
    v_exp_f32 v132, v132
    v_mfma_f32_32x32x16_bf16 v[176:191], v[84:87], v[44:47], 0
    ds_read_b128 v[80:83], v6 offset:20992
    v_exp_f32 v133, v133
    v_exp_f32 v134, v134
    v_exp_f32 v135, v135
    v_exp_f32 v136, v136
    v_exp_f32 v137, v137
    v_smfmac_f32_32x32x32_bf16 v[192:207], v[92:95], v[128:135], v10
    ds_read_b128 v[88:91], v8 offset:25984
    v_exp_f32 v138, v138
    v_exp_f32 v139, v139
    v_exp_f32 v140, v140
    v_exp_f32 v141, v141
    v_mfma_f32_32x32x4_2b_bf16 v[160:191], v[56:57], v[54:55], v[160:191]
    v_exp_f32 v142, v142
    v_exp_f32 v143, v143
    v_exp_f32 v144, v144
    v_exp_f32 v145, v145
    v_exp_f32 v146, v146
    v_exp_f32 v147, v147
    v_exp_f32 v148, v148
    v_exp_f32 v149, v149
    v_smfmac_f32_32x32x32_bf16 v[192:207], v[100:103], v[136:143], v10
    v_exp_f32 v150, v150
    v_exp_f32 v151, v151
    v_exp_f32 v152, v152
    v_exp_f32 v153, v153
    v_smfmac_f32_32x32x32_bf16 v[208:223], v[92:95], v[144:151], v10
    s_waitcnt lgkmcnt(0)
    v_exp_f32 v154, v154
    v_exp_f32 v155, v155
    v_exp_f32 v156, v156
    v_exp_f32 v157, v157
    v_mfma_f32_32x32x16_bf16 v[128:143], v[80:83], v[32:35], 0
    v_exp_f32 v158, v158
    v_exp_f32 v159, v159
    v_exp_f32 v160, v160
    v_exp_f32 v161, v161
    v_smfmac_f32_32x32x32_bf16 v[208:223], v[100:103], v[152:159], v10
    v_exp_f32 v162, v162
    v_exp_f32 v163, v163
    v_exp_f32 v164, v164
    v_mfma_f32_32x32x16_bf16 v[144:159], v[80:83], v[36:39], 0
    v_exp_f32 v165, v165
    v_exp_f32 v166, v166
    v_exp_f32 v167, v167
    v_exp_f32 v168, v168
    v_exp_f32 v169, v169
    v_smfmac_f32_32x32x32_bf16 v[224:239], v[92:95], v[160:167], v10
    v_exp_f32 v170, v170
    v_exp_f32 v171, v171
    v_exp_f32 v172, v172
    v_exp_f32 v173, v173
    v_mfma_f32_32x32x4_2b_bf16 v[128:159], v[58:59], v[48:49], v[128:159]
    v_exp_f32 v174, v174
    v_exp_f32 v175, v175
    v_exp_f32 v176, v176
    v_exp_f32 v177, v177
    v_exp_f32 v178, v178
    v_exp_f32 v179, v179
    v_exp_f32 v180, v180
    v_exp_f32 v181, v181
    v_smfmac_f32_32x32x32_bf16 v[224:239], v[100:103], v[168:175], v10
    v_exp_f32 v182, v182
    v_exp_f32 v183, v183
    v_exp_f32 v184, v184
    v_exp_f32 v185, v185
    v_smfmac_f32_32x32x32_bf16 v[240:255], v[92:95], v[176:183], v10
    v_exp_f32 v186, v186
    v_exp_f32 v187, v187
    v_exp_f32 v188, v188
    v_exp_f32 v189, v189
    v_mfma_f32_32x32x16_bf16 v[160:175], v[80:83], v[40:43], 0
    v_exp_f32 v190, v190
    v_exp_f32 v191, v191
    v_exp_f32 v128, v128
    v_exp_f32 v129, v129
    v_smfmac_f32_32x32x32_bf16 v[240:255], v[100:103], v[184:191], v10
    ds_read_b128 v[100:103], v8 offset:27808
    v_exp_f32 v130, v130
    v_exp_f32 v131, v131
    v_exp_f32 v132, v132
    v_mfma_f32_32x32x16_bf16 v[176:191], v[80:83], v[44:47], 0
    ds_read_b128 v[84:87], v6 offset:22016
    v_exp_f32 v133, v133
    v_exp_f32 v134, v134
    v_exp_f32 v135, v135
    v_exp_f32 v136, v136
    v_exp_f32 v137, v137
    v_smfmac_f32_32x32x32_bf16 v[192:207], v[88:91], v[128:135], v10
    ds_read_b128 v[92:95], v8 offset:27200
    v_exp_f32 v138, v138
    v_exp_f32 v139, v139
    v_exp_f32 v140, v140
    v_exp_f32 v141, v141
    v_mfma_f32_32x32x4_2b_bf16 v[160:191], v[58:59], v[52:53], v[160:191]
    v_exp_f32 v142, v142
    v_exp_f32 v143, v143
    v_exp_f32 v144, v144
    v_exp_f32 v145, v145
    v_exp_f32 v146, v146
    v_exp_f32 v147, v147
    v_exp_f32 v148, v148
    v_exp_f32 v149, v149
    v_smfmac_f32_32x32x32_bf16 v[192:207], v[96:99], v[136:143], v10
    v_exp_f32 v150, v150
    v_exp_f32 v151, v151
    v_exp_f32 v152, v152
    v_exp_f32 v153, v153
    v_smfmac_f32_32x32x32_bf16 v[208:223], v[88:91], v[144:151], v10
    s_waitcnt lgkmcnt(0)
    v_exp_f32 v154, v154
    v_exp_f32 v155, v155
    v_exp_f32 v156, v156
    v_exp_f32 v157, v157
    v_mfma_f32_32x32x16_bf16 v[128:143], v[84:87], v[32:35], 0
    v_exp_f32 v158, v158
    v_exp_f32 v159, v159
    v_exp_f32 v160, v160
    v_exp_f32 v161, v161
    v_smfmac_f32_32x32x32_bf16 v[208:223], v[96:99], v[152:159], v10
    v_exp_f32 v162, v162
    v_exp_f32 v163, v163
    v_exp_f32 v164, v164
    v_mfma_f32_32x32x16_bf16 v[144:159], v[84:87], v[36:39], 0
    v_exp_f32 v165, v165
    v_exp_f32 v166, v166
    v_exp_f32 v167, v167
    v_exp_f32 v168, v168
    v_exp_f32 v169, v169
    v_smfmac_f32_32x32x32_bf16 v[224:239], v[88:91], v[160:167], v10
    v_exp_f32 v170, v170
    v_exp_f32 v171, v171
    v_exp_f32 v172, v172
    v_exp_f32 v173, v173
    v_mfma_f32_32x32x4_2b_bf16 v[128:159], v[58:59], v[50:51], v[128:159]
    v_exp_f32 v174, v174
    v_exp_f32 v175, v175
    v_exp_f32 v176, v176
    v_exp_f32 v177, v177
    v_exp_f32 v178, v178
    v_exp_f32 v179, v179
    v_exp_f32 v180, v180
    v_exp_f32 v181, v181
    v_smfmac_f32_32x32x32_bf16 v[224:239], v[96:99], v[168:175], v10
    v_exp_f32 v182, v182
    v_exp_f32 v183, v183
    v_exp_f32 v184, v184
    v_exp_f32 v185, v185
    v_smfmac_f32_32x32x32_bf16 v[240:255], v[88:91], v[176:183], v10
    v_exp_f32 v186, v186
    v_exp_f32 v187, v187
    v_exp_f32 v188, v188
    v_exp_f32 v189, v189
    v_mfma_f32_32x32x16_bf16 v[160:175], v[84:87], v[40:43], 0
    v_exp_f32 v190, v190
    v_exp_f32 v191, v191
    v_exp_f32 v128, v128
    v_exp_f32 v129, v129
    v_smfmac_f32_32x32x32_bf16 v[240:255], v[96:99], v[184:191], v10
    ds_read_b128 v[96:99], v8 offset:33632
    v_exp_f32 v130, v130
    v_exp_f32 v131, v131
    v_exp_f32 v132, v132
    v_mfma_f32_32x32x16_bf16 v[176:191], v[84:87], v[44:47], 0
    ds_read_b128 v[80:83], v6 offset:28416
    v_exp_f32 v133, v133
    v_exp_f32 v134, v134
    v_exp_f32 v135, v135
    v_exp_f32 v136, v136
    v_exp_f32 v137, v137
    v_smfmac_f32_32x32x32_bf16 v[192:207], v[92:95], v[128:135], v10
    ds_read_b128 v[88:91], v8 offset:33024
    v_exp_f32 v138, v138
    v_exp_f32 v139, v139
    v_exp_f32 v140, v140
    v_exp_f32 v141, v141
    v_mfma_f32_32x32x4_2b_bf16 v[160:191], v[58:59], v[54:55], v[160:191]
    ds_read_b128 v[60:63], v7 offset:32512
    v_exp_f32 v142, v142
    v_exp_f32 v143, v143
    v_exp_f32 v144, v144
    v_exp_f32 v145, v145
    v_exp_f32 v146, v146
    v_exp_f32 v147, v147
    v_exp_f32 v148, v148
    v_exp_f32 v149, v149
    v_smfmac_f32_32x32x32_bf16 v[192:207], v[100:103], v[136:143], v10
    v_exp_f32 v150, v150
    v_exp_f32 v151, v151
    v_exp_f32 v152, v152
    v_exp_f32 v153, v153
    v_smfmac_f32_32x32x32_bf16 v[208:223], v[92:95], v[144:151], v10
    s_waitcnt lgkmcnt(0)
    v_exp_f32 v154, v154
    v_exp_f32 v155, v155
    v_exp_f32 v156, v156
    v_exp_f32 v157, v157
    v_mfma_f32_32x32x16_bf16 v[128:143], v[80:83], v[32:35], 0
    s_cmp_eq_u32 s46, 3
    v_exp_f32 v158, v158
    v_exp_f32 v159, v159
    s_cbranch_scc1 k_last
    v_exp_f32 v160, v160
    v_exp_f32 v161, v161
    v_smfmac_f32_32x32x32_bf16 v[208:223], v[100:103], v[152:159], v10
    v_exp_f32 v162, v162
    v_exp_f32 v163, v163
    v_exp_f32 v164, v164
    v_mfma_f32_32x32x16_bf16 v[144:159], v[80:83], v[36:39], 0
    v_exp_f32 v165, v165
    v_exp_f32 v166, v166
    v_exp_f32 v167, v167
    v_exp_f32 v168, v168
    v_exp_f32 v169, v169
    v_smfmac_f32_32x32x32_bf16 v[224:239], v[92:95], v[160:167], v10
    v_exp_f32 v170, v170
    v_exp_f32 v171, v171
    v_exp_f32 v172, v172
    v_exp_f32 v173, v173
    v_mfma_f32_32x32x4_2b_bf16 v[128:159], v[60:61], v[48:49], v[128:159]
    v_exp_f32 v174, v174
    v_exp_f32 v175, v175
    v_exp_f32 v176, v176
    v_exp_f32 v177, v177
    v_exp_f32 v178, v178
    v_exp_f32 v179, v179
    v_exp_f32 v180, v180
    v_exp_f32 v181, v181
    v_smfmac_f32_32x32x32_bf16 v[224:239], v[100:103], v[168:175], v10
    v_exp_f32 v182, v182
    v_exp_f32 v183, v183
    v_exp_f32 v184, v184
    v_exp_f32 v185, v185
    v_smfmac_f32_32x32x32_bf16 v[240:255], v[92:95], v[176:183], v10
    v_exp_f32 v186, v186
    v_exp_f32 v187, v187
    v_exp_f32 v188, v188
    v_exp_f32 v189, v189
    v_mfma_f32_32x32x16_bf16 v[160:175], v[80:83], v[40:43], 0
    v_exp_f32 v190, v190
    v_exp_f32 v191, v191
    v_exp_f32 v128, v128
    v_exp_f32 v129, v129
    v_smfmac_f32_32x32x32_bf16 v[240:255], v[100:103], v[184:191], v10
    ds_read_b128 v[100:103], v8 offset:34848
    v_exp_f32 v130, v130
    v_exp_f32 v131, v131
    v_exp_f32 v132, v132
    v_mfma_f32_32x32x16_bf16 v[176:191], v[80:83], v[44:47], 0
    ds_read_b128 v[84:87], v6 offset:29440
    v_exp_f32 v133, v133
    v_exp_f32 v134, v134
    v_exp_f32 v135, v135
    v_exp_f32 v136, v136
    v_exp_f32 v137, v137
    v_smfmac_f32_32x32x32_bf16 v[192:207], v[88:91], v[128:135], v10
    ds_read_b128 v[92:95], v8 offset:34240
    v_exp_f32 v138, v138
    v_exp_f32 v139, v139
    v_exp_f32 v140, v140
    v_exp_f32 v141, v141
    v_mfma_f32_32x32x4_2b_bf16 v[160:191], v[60:61], v[52:53], v[160:191]
    v_exp_f32 v142, v142
    v_exp_f32 v143, v143
    v_exp_f32 v144, v144
    v_exp_f32 v145, v145
    v_exp_f32 v146, v146
    v_exp_f32 v147, v147
    v_exp_f32 v148, v148
    v_exp_f32 v149, v149
    v_smfmac_f32_32x32x32_bf16 v[192:207], v[96:99], v[136:143], v10
    v_exp_f32 v150, v150
    v_exp_f32 v151, v151
    v_exp_f32 v152, v152
    v_exp_f32 v153, v153
    v_smfmac_f32_32x32x32_bf16 v[208:223], v[88:91], v[144:151], v10
    s_waitcnt lgkmcnt(0)
    v_exp_f32 v154, v154
    v_exp_f32 v155, v155
    v_exp_f32 v156, v156
    v_exp_f32 v157, v157
    v_mfma_f32_32x32x16_bf16 v[128:143], v[84:87], v[32:35], 0
    v_exp_f32 v158, v158
    v_exp_f32 v159, v159
    v_exp_f32 v160, v160
    v_exp_f32 v161, v161
    v_smfmac_f32_32x32x32_bf16 v[208:223], v[96:99], v[152:159], v10
    v_exp_f32 v162, v162
    v_exp_f32 v163, v163
    v_exp_f32 v164, v164
    v_mfma_f32_32x32x16_bf16 v[144:159], v[84:87], v[36:39], 0
    v_exp_f32 v165, v165
    v_exp_f32 v166, v166
    v_exp_f32 v167, v167
    v_exp_f32 v168, v168
    v_exp_f32 v169, v169
    v_smfmac_f32_32x32x32_bf16 v[224:239], v[88:91], v[160:167], v10
    v_exp_f32 v170, v170
    v_exp_f32 v171, v171
    v_exp_f32 v172, v172
    v_exp_f32 v173, v173
    v_mfma_f32_32x32x4_2b_bf16 v[128:159], v[60:61], v[50:51], v[128:159]
    v_exp_f32 v174, v174
    v_exp_f32 v175, v175
    v_exp_f32 v176, v176
    v_exp_f32 v177, v177
    v_exp_f32 v178, v178
    v_exp_f32 v179, v179
    v_exp_f32 v180, v180
    v_exp_f32 v181, v181
    v_smfmac_f32_32x32x32_bf16 v[224:239], v[96:99], v[168:175], v10
    v_exp_f32 v182, v182
    v_exp_f32 v183, v183
    v_exp_f32 v184, v184
    v_exp_f32 v185, v185
    v_smfmac_f32_32x32x32_bf16 v[240:255], v[88:91], v[176:183], v10
    v_exp_f32 v186, v186
    v_exp_f32 v187, v187
    v_exp_f32 v188, v188
    v_exp_f32 v189, v189
    v_mfma_f32_32x32x16_bf16 v[160:175], v[84:87], v[40:43], 0
    v_exp_f32 v190, v190
    v_exp_f32 v191, v191
    v_exp_f32 v128, v128
    v_exp_f32 v129, v129
    v_smfmac_f32_32x32x32_bf16 v[240:255], v[96:99], v[184:191], v10
    ds_read_b128 v[96:99], v8 offset:36064
    v_exp_f32 v130, v130
    v_exp_f32 v131, v131
    v_exp_f32 v132, v132
    v_mfma_f32_32x32x16_bf16 v[176:191], v[84:87], v[44:47], 0
    ds_read_b128 v[80:83], v6 offset:30464
    v_exp_f32 v133, v133
    v_exp_f32 v134, v134
    v_exp_f32 v135, v135
    v_exp_f32 v136, v136
    v_exp_f32 v137, v137
    v_smfmac_f32_32x32x32_bf16 v[192:207], v[92:95], v[128:135], v10
    ds_read_b128 v[88:91], v8 offset:35456
    v_exp_f32 v138, v138
    v_exp_f32 v139, v139
    v_exp_f32 v140, v140
    v_exp_f32 v141, v141
    v_mfma_f32_32x32x4_2b_bf16 v[160:191], v[60:61], v[54:55], v[160:191]
    v_exp_f32 v142, v142
    v_exp_f32 v143, v143
    v_exp_f32 v144, v144
    v_exp_f32 v145, v145
    v_exp_f32 v146, v146
    v_exp_f32 v147, v147
    v_exp_f32 v148, v148
    v_exp_f32 v149, v149
    v_smfmac_f32_32x32x32_bf16 v[192:207], v[100:103], v[136:143], v10
    v_exp_f32 v150, v150
    v_exp_f32 v151, v151
    v_exp_f32 v152, v152
    v_exp_f32 v153, v153
    v_smfmac_f32_32x32x32_bf16 v[208:223], v[92:95], v[144:151], v10
    s_waitcnt lgkmcnt(0)
    v_exp_f32 v154, v154
    v_exp_f32 v155, v155
    v_exp_f32 v156, v156
    v_exp_f32 v157, v157
    v_mfma_f32_32x32x16_bf16 v[128:143], v[80:83], v[32:35], 0
    v_exp_f32 v158, v158
    v_exp_f32 v159, v159
    v_exp_f32 v160, v160
    v_exp_f32 v161, v161
    v_smfmac_f32_32x32x32_bf16 v[208:223], v[100:103], v[152:159], v10
    v_exp_f32 v162, v162
    v_exp_f32 v163, v163
    v_exp_f32 v164, v164
    v_mfma_f32_32x32x16_bf16 v[144:159], v[80:83], v[36:39], 0
    v_exp_f32 v165, v165
    v_exp_f32 v166, v166
    v_exp_f32 v167, v167
    v_exp_f32 v168, v168
    v_exp_f32 v169, v169
    v_smfmac_f32_32x32x32_bf16 v[224:239], v[92:95], v[160:167], v10
    v_exp_f32 v170, v170
    v_exp_f32 v171, v171
    v_exp_f32 v172, v172
    v_exp_f32 v173, v173
    v_mfma_f32_32x32x4_2b_bf16 v[128:159], v[62:63], v[48:49], v[128:159]
    v_exp_f32 v174, v174
    v_exp_f32 v175, v175
    v_exp_f32 v176, v176
    v_exp_f32 v177, v177
    v_exp_f32 v178, v178
    v_exp_f32 v179, v179
    v_exp_f32 v180, v180
    v_exp_f32 v181, v181
    v_smfmac_f32_32x32x32_bf16 v[224:239], v[100:103], v[168:175], v10
    v_exp_f32 v182, v182
    v_exp_f32 v183, v183
    v_exp_f32 v184, v184
    v_exp_f32 v185, v185
    v_smfmac_f32_32x32x32_bf16 v[240:255], v[92:95], v[176:183], v10
    v_exp_f32 v186, v186
    v_exp_f32 v187, v187
    v_exp_f32 v188, v188
    v_exp_f32 v189, v189
    v_mfma_f32_32x32x16_bf16 v[160:175], v[80:83], v[40:43], 0
    v_exp_f32 v190, v190
    v_exp_f32 v191, v191
    v_exp_f32 v128, v128
    v_exp_f32 v129, v129
    v_smfmac_f32_32x32x32_bf16 v[240:255], v[100:103], v[184:191], v10
    ds_read_b128 v[100:103], v8 offset:37280
    v_exp_f32 v130, v130
    v_exp_f32 v131, v131
    v_exp_f32 v132, v132
    v_mfma_f32_32x32x16_bf16 v[176:191], v[80:83], v[44:47], 0
    ds_read_b128 v[84:87], v6 offset:31488
    v_exp_f32 v133, v133
    v_exp_f32 v134, v134
    v_exp_f32 v135, v135
    v_exp_f32 v136, v136
    v_exp_f32 v137, v137
    v_smfmac_f32_32x32x32_bf16 v[192:207], v[88:91], v[128:135], v10
    ds_read_b128 v[92:95], v8 offset:36672
    v_exp_f32 v138, v138
    v_exp_f32 v139, v139
    v_exp_f32 v140, v140
    v_exp_f32 v141, v141
    v_mfma_f32_32x32x4_2b_bf16 v[160:191], v[62:63], v[52:53], v[160:191]
    v_exp_f32 v142, v142
    v_exp_f32 v143, v143
    v_exp_f32 v144, v144
    v_exp_f32 v145, v145
    v_exp_f32 v146, v146
    v_exp_f32 v147, v147
    v_exp_f32 v148, v148
    v_exp_f32 v149, v149
    v_smfmac_f32_32x32x32_bf16 v[192:207], v[96:99], v[136:143], v10
    v_exp_f32 v150, v150
    v_exp_f32 v151, v151
    v_exp_f32 v152, v152
    v_exp_f32 v153, v153
    v_smfmac_f32_32x32x32_bf16 v[208:223], v[88:91], v[144:151], v10
    s_waitcnt lgkmcnt(0)
    v_exp_f32 v154, v154
    v_exp_f32 v155, v155
    v_exp_f32 v156, v156
    v_exp_f32 v157, v157
    v_mfma_f32_32x32x16_bf16 v[128:143], v[84:87], v[32:35], 0
    v_exp_f32 v158, v158
    v_exp_f32 v159, v159
    v_exp_f32 v160, v160
    v_exp_f32 v161, v161
    v_smfmac_f32_32x32x32_bf16 v[208:223], v[96:99], v[152:159], v10
    s_cmp_eq_u32 s46, 1
    v_exp_f32 v162, v162
    v_exp_f32 v163, v163
    v_exp_f32 v164, v164
    v_mfma_f32_32x32x16_bf16 v[144:159], v[84:87], v[36:39], 0
    s_cselect_b32 s37, s63, s62
    v_exp_f32 v165, v165
    v_exp_f32 v166, v166
    v_exp_f32 v167, v167
    v_exp_f32 v168, v168
    v_exp_f32 v169, v169
    v_smfmac_f32_32x32x32_bf16 v[224:239], v[88:91], v[160:167], v10
    v_add_u32 v6, s37, v6
    v_exp_f32 v170, v170
    v_exp_f32 v171, v171
    v_exp_f32 v172, v172
    v_exp_f32 v173, v173
    v_mfma_f32_32x32x4_2b_bf16 v[128:159], v[62:63], v[50:51], v[128:159]
    v_add_u32 v7, s37, v7
    v_exp_f32 v174, v174
    v_exp_f32 v175, v175
    v_exp_f32 v176, v176
    v_exp_f32 v177, v177
    v_exp_f32 v178, v178
    v_exp_f32 v179, v179
    v_exp_f32 v180, v180
    v_exp_f32 v181, v181
    v_smfmac_f32_32x32x32_bf16 v[224:239], v[96:99], v[168:175], v10
    v_add_u32 v8, s37, v8
    v_exp_f32 v182, v182
    v_exp_f32 v183, v183
    v_exp_f32 v184, v184
    v_exp_f32 v185, v185
    v_smfmac_f32_32x32x32_bf16 v[240:255], v[88:91], v[176:183], v10
    s_add_u32 s46, s46, 1
    v_exp_f32 v186, v186
    v_exp_f32 v187, v187
    v_exp_f32 v188, v188
    v_exp_f32 v189, v189
    v_mfma_f32_32x32x16_bf16 v[160:175], v[84:87], v[40:43], 0
    s_barrier
    v_exp_f32 v190, v190
    v_exp_f32 v191, v191
    v_exp_f32 v128, v128
    v_exp_f32 v129, v129
    v_smfmac_f32_32x32x32_bf16 v[240:255], v[96:99], v[184:191], v10
    ds_read_b128 v[96:99], v8 offset:5216
    v_exp_f32 v130, v130
    v_exp_f32 v131, v131
    v_exp_f32 v132, v132
    v_mfma_f32_32x32x16_bf16 v[176:191], v[84:87], v[44:47], 0
    ds_read_b128 v[80:83], v6 offset:0
    v_exp_f32 v133, v133
    v_exp_f32 v134, v134
    v_exp_f32 v135, v135
    v_exp_f32 v136, v136
    v_exp_f32 v137, v137
    v_smfmac_f32_32x32x32_bf16 v[192:207], v[92:95], v[128:135], v10
    ds_read_b128 v[88:91], v8 offset:4608
    v_exp_f32 v138, v138
    v_exp_f32 v139, v139
    v_exp_f32 v140, v140
    v_exp_f32 v141, v141
    v_mfma_f32_32x32x4_2b_bf16 v[160:191], v[62:63], v[54:55], v[160:191]
    ds_read_b128 v[56:59], v7 offset:4096
    v_exp_f32 v142, v142
    v_exp_f32 v143, v143
    v_exp_f32 v144, v144
    v_exp_f32 v145, v145
    v_exp_f32 v146, v146
    v_exp_f32 v147, v147
    v_exp_f32 v148, v148
    v_exp_f32 v149, v149
    v_smfmac_f32_32x32x32_bf16 v[192:207], v[100:103], v[136:143], v10
    v_exp_f32 v150, v150
    v_exp_f32 v151, v151
    v_exp_f32 v152, v152
    v_exp_f32 v153, v153
    v_smfmac_f32_32x32x32_bf16 v[208:223], v[92:95], v[144:151], v10
    s_waitcnt lgkmcnt(0)
    v_exp_f32 v154, v154
    v_exp_f32 v155, v155
    v_exp_f32 v156, v156
    v_exp_f32 v157, v157
    v_mfma_f32_32x32x16_bf16 v[128:143], v[80:83], v[32:35], 0
    v_exp_f32 v158, v158
    v_exp_f32 v159, v159
    v_exp_f32 v160, v160
    v_exp_f32 v161, v161
    v_smfmac_f32_32x32x32_bf16 v[208:223], v[100:103], v[152:159], v10
    v_exp_f32 v162, v162
    v_exp_f32 v163, v163
    v_exp_f32 v164, v164
    v_mfma_f32_32x32x16_bf16 v[144:159], v[80:83], v[36:39], 0
    v_exp_f32 v165, v165
    v_exp_f32 v166, v166
    v_exp_f32 v167, v167
    v_exp_f32 v168, v168
    v_exp_f32 v169, v169
    v_smfmac_f32_32x32x32_bf16 v[224:239], v[92:95], v[160:167], v10
    v_exp_f32 v170, v170
    v_exp_f32 v171, v171
    v_exp_f32 v172, v172
    v_exp_f32 v173, v173
    v_mfma_f32_32x32x4_2b_bf16 v[128:159], v[56:57], v[48:49], v[128:159]
    v_exp_f32 v174, v174
    v_exp_f32 v175, v175
    v_exp_f32 v176, v176
    v_exp_f32 v177, v177
    v_exp_f32 v178, v178
    v_exp_f32 v179, v179
    v_exp_f32 v180, v180
    v_exp_f32 v181, v181
    v_smfmac_f32_32x32x32_bf16 v[224:239], v[100:103], v[168:175], v10
    v_exp_f32 v182, v182
    v_exp_f32 v183, v183
    v_exp_f32 v184, v184
    v_exp_f32 v185, v185
    v_smfmac_f32_32x32x32_bf16 v[240:255], v[92:95], v[176:183], v10
    v_exp_f32 v186, v186
    v_exp_f32 v187, v187
    v_exp_f32 v188, v188
    v_exp_f32 v189, v189
    v_mfma_f32_32x32x16_bf16 v[160:175], v[80:83], v[40:43], 0
    v_exp_f32 v190, v190
    v_exp_f32 v191, v191
    s_branch k_att
k_last:
    v_exp_f32 v160, v160
    v_exp_f32 v161, v161
    v_smfmac_f32_32x32x32_bf16 v[208:223], v[100:103], v[152:159], v10
    v_exp_f32 v162, v162
    v_exp_f32 v163, v163
    v_exp_f32 v164, v164
    v_mfma_f32_32x32x16_bf16 v[144:159], v[80:83], v[36:39], 0
    ds_read_b128 v[84:87], v6 offset:29440
    v_exp_f32 v165, v165
    v_exp_f32 v166, v166
    v_exp_f32 v167, v167
    v_exp_f32 v168, v168
    v_exp_f32 v169, v169
    v_smfmac_f32_32x32x32_bf16 v[224:239], v[92:95], v[160:167], v10
    v_exp_f32 v170, v170
    v_exp_f32 v171, v171
    v_exp_f32 v172, v172
    v_exp_f32 v173, v173
    v_mfma_f32_32x32x4_2b_bf16 v[128:159], v[60:61], v[48:49], v[128:159]
    s_add_u32 s40, s70, 4096
    buffer_load_dwordx4 v[64:67], v16, s[28:31], s40 offen offset:0 sc1
    v_exp_f32 v174, v174
    v_exp_f32 v175, v175
    v_exp_f32 v176, v176
    v_exp_f32 v177, v177
    v_exp_f32 v178, v178
    v_exp_f32 v179, v179
    v_exp_f32 v180, v180
    v_exp_f32 v181, v181
    v_smfmac_f32_32x32x32_bf16 v[224:239], v[100:103], v[168:175], v10
    s_add_u32 s40, s70, 13312
    buffer_load_dwordx4 v[68:71], v16, s[28:31], s40 offen offset:0 sc1
    v_exp_f32 v182, v182
    v_exp_f32 v183, v183
    v_exp_f32 v184, v184
    v_exp_f32 v185, v185
    v_smfmac_f32_32x32x32_bf16 v[240:255], v[92:95], v[176:183], v10
    s_waitcnt lgkmcnt(0)
    v_exp_f32 v186, v186
    v_exp_f32 v187, v187
    v_exp_f32 v188, v188
    v_exp_f32 v189, v189
    v_mfma_f32_32x32x16_bf16 v[160:175], v[84:87], v[32:35], 0
    v_exp_f32 v190, v190
    v_exp_f32 v191, v191
    v_exp_f32 v128, v128
    v_exp_f32 v129, v129
    v_smfmac_f32_32x32x32_bf16 v[240:255], v[100:103], v[184:191], v10
    ds_read_b128 v[100:103], v8 offset:34848
    v_exp_f32 v130, v130
    v_exp_f32 v131, v131
    v_exp_f32 v132, v132
    v_mfma_f32_32x32x16_bf16 v[176:191], v[84:87], v[36:39], 0
    ds_read_b128 v[80:83], v6 offset:30464
    v_exp_f32 v133, v133
    v_exp_f32 v134, v134
    v_exp_f32 v135, v135
    v_exp_f32 v136, v136
    v_exp_f32 v137, v137
    v_smfmac_f32_32x32x32_bf16 v[192:207], v[88:91], v[128:135], v10
    ds_read_b128 v[92:95], v8 offset:34240
    v_exp_f32 v138, v138
    v_exp_f32 v139, v139
    v_exp_f32 v140, v140
    v_exp_f32 v141, v141
    v_mfma_f32_32x32x4_2b_bf16 v[160:191], v[60:61], v[50:51], v[160:191]
    s_add_u32 s40, s70, 22528
    buffer_load_dwordx4 v[72:75], v16, s[28:31], s40 offen offset:0 sc1
    v_exp_f32 v142, v142
    v_exp_f32 v143, v143
    v_exp_f32 v144, v144
    v_exp_f32 v145, v145
    v_exp_f32 v146, v146
    v_exp_f32 v147, v147
    v_exp_f32 v148, v148
    v_exp_f32 v149, v149
    v_smfmac_f32_32x32x32_bf16 v[192:207], v[96:99], v[136:143], v10
    s_add_u32 s40, s70, 31744
    buffer_load_dwordx4 v[76:79], v16, s[28:31], s40 offen offset:0 sc1
    v_exp_f32 v150, v150
    v_exp_f32 v151, v151
    v_exp_f32 v152, v152
    v_exp_f32 v153, v153
    v_smfmac_f32_32x32x32_bf16 v[208:223], v[88:91], v[144:151], v10
    s_waitcnt lgkmcnt(0)
    v_exp_f32 v154, v154
    v_exp_f32 v155, v155
    v_exp_f32 v156, v156
    v_exp_f32 v157, v157
    v_mfma_f32_32x32x16_bf16 v[128:143], v[80:83], v[32:35], 0
    v_exp_f32 v158, v158
    v_exp_f32 v159, v159
    v_exp_f32 v160, v160
    v_exp_f32 v161, v161
    v_smfmac_f32_32x32x32_bf16 v[208:223], v[96:99], v[152:159], v10
    ds_read_b128 v[96:99], v8 offset:36064
    v_exp_f32 v162, v162
    v_exp_f32 v163, v163
    v_exp_f32 v164, v164
    v_mfma_f32_32x32x16_bf16 v[144:159], v[80:83], v[36:39], 0
    ds_read_b128 v[84:87], v6 offset:31488
    v_exp_f32 v165, v165
    v_exp_f32 v166, v166
    v_exp_f32 v167, v167
    v_exp_f32 v168, v168
    v_exp_f32 v169, v169
    v_smfmac_f32_32x32x32_bf16 v[192:207], v[92:95], v[160:167], v10
    ds_read_b128 v[88:91], v8 offset:35456
    v_exp_f32 v170, v170
    v_exp_f32 v171, v171
    v_exp_f32 v172, v172
    v_exp_f32 v173, v173
    v_mfma_f32_32x32x4_2b_bf16 v[128:159], v[62:63], v[48:49], v[128:159]
    s_add_u32 s40, s71, 4096
    buffer_load_dwordx4 v[104:107], v16, s[28:31], s40 offen offset:0 sc1
    v_exp_f32 v174, v174
    v_exp_f32 v175, v175
    v_exp_f32 v176, v176
    v_exp_f32 v177, v177
    v_exp_f32 v178, v178
    v_exp_f32 v179, v179
    v_exp_f32 v180, v180
    v_exp_f32 v181, v181
    v_smfmac_f32_32x32x32_bf16 v[192:207], v[100:103], v[168:175], v10
    s_add_u32 s40, s71, 13312
    buffer_load_dwordx4 v[108:111], v16, s[28:31], s40 offen offset:0 sc1
    v_exp_f32 v182, v182
    v_exp_f32 v183, v183
    v_exp_f32 v184, v184
    v_exp_f32 v185, v185
    v_smfmac_f32_32x32x32_bf16 v[208:223], v[92:95], v[176:183], v10
    s_waitcnt lgkmcnt(0)
    v_exp_f32 v186, v186
    v_exp_f32 v187, v187
    v_exp_f32 v188, v188
    v_exp_f32 v189, v189
    v_mfma_f32_32x32x16_bf16 v[160:175], v[84:87], v[32:35], 0
    v_exp_f32 v190, v190
    v_exp_f32 v191, v191
    v_exp_f32 v128, v128
    v_exp_f32 v129, v129
    v_smfmac_f32_32x32x32_bf16 v[208:223], v[100:103], v[184:191], v10
    ds_read_b128 v[100:103], v8 offset:37280
    v_exp_f32 v130, v130
    v_exp_f32 v131, v131
    v_exp_f32 v132, v132
    v_mfma_f32_32x32x16_bf16 v[176:191], v[84:87], v[36:39], 0
    ds_read_b128 v[80:83], v6 offset:28416
    v_exp_f32 v133, v133
    v_exp_f32 v134, v134
    v_exp_f32 v135, v135
    v_exp_f32 v136, v136
    v_exp_f32 v137, v137
    v_smfmac_f32_32x32x32_bf16 v[192:207], v[88:91], v[128:135], v10
    ds_read_b128 v[92:95], v8 offset:36672
    v_exp_f32 v138, v138
    v_exp_f32 v139, v139
    v_exp_f32 v140, v140
    v_exp_f32 v141, v141
    v_mfma_f32_32x32x4_2b_bf16 v[160:191], v[62:63], v[50:51], v[160:191]
    s_add_u32 s40, s71, 22528
    buffer_load_dwordx4 v[112:115], v16, s[28:31], s40 offen offset:0 sc1
    v_exp_f32 v142, v142
    v_exp_f32 v143, v143
    v_exp_f32 v144, v144
    v_exp_f32 v145, v145
    v_exp_f32 v146, v146
    v_exp_f32 v147, v147
    v_exp_f32 v148, v148
    v_exp_f32 v149, v149
    v_smfmac_f32_32x32x32_bf16 v[192:207], v[96:99], v[136:143], v10
    s_add_u32 s40, s71, 31744
    buffer_load_dwordx4 v[116:119], v16, s[28:31], s40 offen offset:0 sc1
    v_exp_f32 v150, v150
    v_exp_f32 v151, v151
    v_exp_f32 v152, v152
    v_exp_f32 v153, v153
    v_smfmac_f32_32x32x32_bf16 v[208:223], v[88:91], v[144:151], v10
    s_waitcnt lgkmcnt(0)
    v_exp_f32 v154, v154
    v_exp_f32 v155, v155
    v_exp_f32 v156, v156
    v_exp_f32 v157, v157
    v_mfma_f32_32x32x16_bf16 v[128:143], v[80:83], v[40:43], 0
    v_exp_f32 v158, v158
    v_exp_f32 v159, v159
    v_exp_f32 v160, v160
    v_exp_f32 v161, v161
    v_smfmac_f32_32x32x32_bf16 v[208:223], v[96:99], v[152:159], v10
    ds_read_b128 v[96:99], v8 offset:33632
    v_exp_f32 v162, v162
    v_exp_f32 v163, v163
    v_exp_f32 v164, v164
    v_mfma_f32_32x32x16_bf16 v[144:159], v[80:83], v[44:47], 0
    ds_read_b128 v[84:87], v6 offset:29440
    v_exp_f32 v165, v165
    v_exp_f32 v166, v166
    v_exp_f32 v167, v167
    v_exp_f32 v168, v168
    v_exp_f32 v169, v169
    v_smfmac_f32_32x32x32_bf16 v[192:207], v[92:95], v[160:167], v10
    ds_read_b128 v[88:91], v8 offset:33024
    v_exp_f32 v170, v170
    v_exp_f32 v171, v171
    v_exp_f32 v172, v172
    v_exp_f32 v173, v173
    v_mfma_f32_32x32x4_2b_bf16 v[128:159], v[60:61], v[52:53], v[128:159]
    buffer_load_dwordx4 v[120:123], v17, s[28:31], s92 offen offset:2048 sc1
    v_exp_f32 v174, v174
    v_exp_f32 v175, v175
    v_exp_f32 v176, v176
    v_exp_f32 v177, v177
    v_exp_f32 v178, v178
    v_exp_f32 v179, v179
    v_exp_f32 v180, v180
    v_exp_f32 v181, v181
    v_smfmac_f32_32x32x32_bf16 v[192:207], v[100:103], v[168:175], v10
    v_exp_f32 v182, v182
    v_exp_f32 v183, v183
    v_exp_f32 v184, v184
    v_exp_f32 v185, v185
    v_smfmac_f32_32x32x32_bf16 v[208:223], v[92:95], v[176:183], v10
    s_waitcnt lgkmcnt(0)
    v_exp_f32 v186, v186
    v_exp_f32 v187, v187
    v_exp_f32 v188, v188
    v_exp_f32 v189, v189
    v_mfma_f32_32x32x16_bf16 v[160:175], v[84:87], v[40:43], 0
    v_exp_f32 v190, v190
    v_exp_f32 v191, v191
    v_exp_f32 v128, v128
    v_exp_f32 v129, v129
    v_smfmac_f32_32x32x32_bf16 v[208:223], v[100:103], v[184:191], v10
    ds_read_b128 v[100:103], v8 offset:34848
    v_exp_f32 v130, v130
    v_exp_f32 v131, v131
    v_exp_f32 v132, v132
    v_mfma_f32_32x32x16_bf16 v[176:191], v[84:87], v[44:47], 0
    ds_read_b128 v[80:83], v6 offset:30464
    v_exp_f32 v133, v133
    v_exp_f32 v134, v134
    v_exp_f32 v135, v135
    v_exp_f32 v136, v136
    v_exp_f32 v137, v137
    v_smfmac_f32_32x32x32_bf16 v[224:239], v[88:91], v[128:135], v10
    ds_read_b128 v[92:95], v8 offset:34240
    v_exp_f32 v138, v138
    v_exp_f32 v139, v139
    v_exp_f32 v140, v140
    v_exp_f32 v141, v141
    v_mfma_f32_32x32x4_2b_bf16 v[160:191], v[60:61], v[54:55], v[160:191]
    v_lshlrev_b32 v26, 16, v26
    v_lshlrev_b32 v27, 16, v27
    v_lshlrev_b32 v28, 16, v28
    v_lshlrev_b32 v29, 16, v29
    v_mul_f32 v26, s60, v26
    v_mul_f32 v27, s60, v27
    v_mul_f32 v28, s60, v28
    v_mul_f32 v29, s60, v29
    v_exp_f32 v26, v26
    v_exp_f32 v27, v27
    v_exp_f32 v28, v28
    v_exp_f32 v29, v29
    s_mov_b32 s7, 0
    v_add_f32 v2, v202, v218
    v_min_f32 v3, v202, v218
    v_cmp_ge_f32 s[52:53], s64, v2
    v_cmp_le_f32 vcc, s61, v3
    s_nop 1
    s_and_b32 vcc_lo, vcc_lo, s52
    s_cmp_eq_u32 vcc_lo, -1
    s_cbranch_scc0 k_defer
    s_mov_b32 s7, -1
    v_mov_b32 v2, v202
    v_mov_b32 v3, v218
    s_nop 0
    v_permlane32_swap_b32 v202, v2
    v_permlane32_swap_b32 v218, v3
    v_fma_f32 v2, v202, v26, v202
    v_fma_f32 v3, v218, v27, v218
    v_rcp_f32 v2, v2
    v_rcp_f32 v3, v3
    s_nop 0
    v_pk_mul_f32 v[192:193], v[192:193], v[2:3] op_sel_hi:[1,0]
    v_pk_mul_f32 v[194:195], v[194:195], v[2:3] op_sel_hi:[1,0]
    v_pk_mul_f32 v[196:197], v[196:197], v[2:3] op_sel_hi:[1,0]
    v_pk_mul_f32 v[198:199], v[198:199], v[2:3] op_sel_hi:[1,0]
    v_pk_mul_f32 v[200:201], v[200:201], v[2:3] op_sel_hi:[1,0]
    v_cvt_pk_bf16_f32 v204, v192, v193
    v_cvt_pk_bf16_f32 v205, v194, v195
    v_cvt_pk_bf16_f32 v206, v196, v197
    v_cvt_pk_bf16_f32 v207, v198, v199
    v_cvt_pk_bf16_f32 v203, v200, v201
    buffer_store_dwordx4 v[204:207], v14, s[28:31], s56 offen sc1
    v_pk_mul_f32 v[208:209], v[208:209], v[2:3] op_sel:[0,1]
    v_pk_mul_f32 v[210:211], v[210:211], v[2:3] op_sel:[0,1]
    v_pk_mul_f32 v[212:213], v[212:213], v[2:3] op_sel:[0,1]
    v_pk_mul_f32 v[214:215], v[214:215], v[2:3] op_sel:[0,1]
    v_pk_mul_f32 v[216:217], v[216:217], v[2:3] op_sel:[0,1]
    v_cvt_pk_bf16_f32 v220, v208, v209
    v_cvt_pk_bf16_f32 v221, v210, v211
    v_cvt_pk_bf16_f32 v222, v212, v213
    v_cvt_pk_bf16_f32 v223, v214, v215
    v_cvt_pk_bf16_f32 v219, v216, v217
    buffer_store_dwordx4 v[220:223], v14, s[28:31], s57 offen sc1
    s_nop 0
    v_permlane32_swap_b32 v203, v219
    buffer_store_dword v203, v15, s[28:31], s4 offen sc1
k_defer:
    v_exp_f32 v142, v142
    v_exp_f32 v143, v143
    v_exp_f32 v144, v144
    v_exp_f32 v145, v145
    v_exp_f32 v146, v146
    v_exp_f32 v147, v147
    v_exp_f32 v148, v148
    v_exp_f32 v149, v149
    v_smfmac_f32_32x32x32_bf16 v[224:239], v[96:99], v[136:143], v10
    v_exp_f32 v150, v150
    v_exp_f32 v151, v151
    v_exp_f32 v152, v152
    v_exp_f32 v153, v153
    v_smfmac_f32_32x32x32_bf16 v[240:255], v[88:91], v[144:151], v10
    s_waitcnt lgkmcnt(0)
    v_exp_f32 v154, v154
    v_exp_f32 v155, v155
    v_exp_f32 v156, v156
    v_exp_f32 v157, v157
    v_mfma_f32_32x32x16_bf16 v[128:143], v[80:83], v[40:43], 0
    v_exp_f32 v158, v158
    v_exp_f32 v159, v159
    v_exp_f32 v160, v160
    v_exp_f32 v161, v161
    v_smfmac_f32_32x32x32_bf16 v[240:255], v[96:99], v[152:159], v10
    ds_read_b128 v[96:99], v8 offset:36064
    v_exp_f32 v162, v162
    v_exp_f32 v163, v163
    v_exp_f32 v164, v164
    v_mfma_f32_32x32x16_bf16 v[144:159], v[80:83], v[44:47], 0
    ds_read_b128 v[84:87], v6 offset:31488
    v_exp_f32 v165, v165
    v_exp_f32 v166, v166
    v_exp_f32 v167, v167
    v_exp_f32 v168, v168
    v_exp_f32 v169, v169
    v_smfmac_f32_32x32x32_bf16 v[224:239], v[92:95], v[160:167], v10
    ds_read_b128 v[88:91], v8 offset:35456
    v_exp_f32 v170, v170
    v_exp_f32 v171, v171
    v_exp_f32 v172, v172
    v_exp_f32 v173, v173
    v_mfma_f32_32x32x4_2b_bf16 v[128:159], v[62:63], v[52:53], v[128:159]
    v_exp_f32 v174, v174
    v_exp_f32 v175, v175
    v_exp_f32 v176, v176
    v_exp_f32 v177, v177
    v_exp_f32 v178, v178
    v_exp_f32 v179, v179
    v_exp_f32 v180, v180
    v_exp_f32 v181, v181
    v_smfmac_f32_32x32x32_bf16 v[224:239], v[100:103], v[168:175], v10
    v_exp_f32 v182, v182
    v_exp_f32 v183, v183
    v_exp_f32 v184, v184
    v_exp_f32 v185, v185
    v_smfmac_f32_32x32x32_bf16 v[240:255], v[92:95], v[176:183], v10
    s_waitcnt lgkmcnt(0)
    v_exp_f32 v186, v186
    v_exp_f32 v187, v187
    v_exp_f32 v188, v188
    v_exp_f32 v189, v189
    v_mfma_f32_32x32x16_bf16 v[160:175], v[84:87], v[40:43], 0
    v_exp_f32 v190, v190
    v_exp_f32 v191, v191
    v_exp_f32 v128, v128
    v_exp_f32 v129, v129
    v_smfmac_f32_32x32x32_bf16 v[240:255], v[100:103], v[184:191], v10
    ds_read_b128 v[100:103], v8 offset:37280
    v_exp_f32 v130, v130
    v_exp_f32 v131, v131
    v_exp_f32 v132, v132
    v_mfma_f32_32x32x16_bf16 v[176:191], v[84:87], v[44:47], 0
    v_exp_f32 v133, v133
    v_exp_f32 v134, v134
    v_exp_f32 v135, v135
    v_exp_f32 v136, v136
    v_exp_f32 v137, v137
    v_smfmac_f32_32x32x32_bf16 v[224:239], v[88:91], v[128:135], v10
    ds_read_b128 v[92:95], v8 offset:36672
    v_exp_f32 v138, v138
    v_exp_f32 v139, v139
    v_exp_f32 v140, v140
    v_exp_f32 v141, v141
    v_mfma_f32_32x32x4_2b_bf16 v[160:191], v[62:63], v[54:55], v[160:191]
    v_exp_f32 v142, v142
    v_exp_f32 v143, v143
    v_exp_f32 v144, v144
    v_exp_f32 v145, v145
    v_exp_f32 v146, v146
    v_exp_f32 v147, v147
    v_exp_f32 v148, v148
    v_exp_f32 v149, v149
    v_smfmac_f32_32x32x32_bf16 v[224:239], v[96:99], v[136:143], v10
    v_exp_f32 v150, v150
    v_exp_f32 v151, v151
    v_exp_f32 v152, v152
    v_exp_f32 v153, v153
    v_smfmac_f32_32x32x32_bf16 v[240:255], v[88:91], v[144:151], v10
    s_waitcnt lgkmcnt(0)
    v_exp_f32 v154, v154
    v_exp_f32 v155, v155
    v_exp_f32 v156, v156
    v_exp_f32 v157, v157
    s_barrier
    v_exp_f32 v158, v158
    v_exp_f32 v159, v159
    v_exp_f32 v160, v160
    v_exp_f32 v161, v161
    v_smfmac_f32_32x32x32_bf16 v[240:255], v[96:99], v[152:159], v10
    v_exp_f32 v162, v162
    v_exp_f32 v163, v163
    v_exp_f32 v164, v164
    v_exp_f32 v165, v165
    v_exp_f32 v166, v166
    v_exp_f32 v167, v167
    v_exp_f32 v168, v168
    v_exp_f32 v169, v169
    v_smfmac_f32_32x32x32_bf16 v[224:239], v[92:95], v[160:167], v10
    v_exp_f32 v170, v170
    v_exp_f32 v171, v171
    v_exp_f32 v172, v172
    v_exp_f32 v173, v173
    v_exp_f32 v174, v174
    v_exp_f32 v175, v175
    v_exp_f32 v176, v176
    v_exp_f32 v177, v177
    v_exp_f32 v178, v178
    v_exp_f32 v179, v179
    v_exp_f32 v180, v180
    v_exp_f32 v181, v181
    v_smfmac_f32_32x32x32_bf16 v[224:239], v[100:103], v[168:175], v10
    v_exp_f32 v182, v182
    v_exp_f32 v183, v183
    v_exp_f32 v184, v184
    v_exp_f32 v185, v185
    v_smfmac_f32_32x32x32_bf16 v[240:255], v[92:95], v[176:183], v10
    v_exp_f32 v186, v186
    v_exp_f32 v187, v187
    v_exp_f32 v188, v188
    v_exp_f32 v189, v189
    v_exp_f32 v190, v190
    v_exp_f32 v191, v191
    s_nop 1
    v_smfmac_f32_32x32x32_bf16 v[240:255], v[100:103], v[184:191], v10
    s_nop 10
    s_and_b32 s64, s64, s7
    v_add_f32 v2, v234, v250
    v_min_f32 v3, v234, v250
    v_cmp_ge_f32 s[52:53], s64, v2
    v_cmp_le_f32 vcc, s61, v3
    s_nop 1
    s_and_b32 vcc_lo, vcc_lo, s52
    s_cmp_eq_u32 vcc_lo, -1
    s_cbranch_scc0 k_fbchk
k_fbdone:
    v_mov_b32 v4, v234
    v_mov_b32 v5, v250
    ds_read_b128 v[32:35], v18 offset:0
    ds_read_b128 v[36:39], v18 offset:1024
    ds_read_b128 v[40:43], v18 offset:2048
    ds_read_b128 v[44:47], v18 offset:3072
    ds_read_b128 v[48:51], v18 offset:4096
    ds_read_b128 v[52:55], v18 offset:5120
    ds_read_b128 v[56:59], v18 offset:6144
    ds_read_b128 v[60:63], v18 offset:7168
    ds_read_b128 v[80:83], v18 offset:8192
    ds_read_b128 v[84:87], v18 offset:9216
    ds_read_b128 v[88:91], v18 offset:10240
    ds_read_b128 v[92:95], v18 offset:11264
    ds_read_b128 v[96:99], v18 offset:12288
    ds_read_b128 v[100:103], v18 offset:13312
    v_permlane32_swap_b32 v234, v4
    v_permlane32_swap_b32 v250, v5
    v_fma_f32 v4, v234, v28, v234
    v_fma_f32 v5, v250, v29, v250
    v_rcp_f32 v4, v4
    v_rcp_f32 v5, v5
    ds_read_b128 v[124:127], v18 offset:14336
    ds_read_b128 v[128:131], v18 offset:15360
    ds_read_b128 v[132:135], v18 offset:16384
    ds_read_b128 v[136:139], v18 offset:17408
    ds_read_b128 v[140:143], v18 offset:18432
    ds_read_b128 v[144:147], v18 offset:19456
    ds_read_b128 v[148:151], v18 offset:20480
    ds_read_b128 v[152:155], v18 offset:21504
    ds_read_b128 v[156:159], v18 offset:22528
    ds_read_b128 v[160:163], v18 offset:23552
    ds_read_b128 v[164:167], v18 offset:24576
    ds_read_b128 v[168:171], v18 offset:25600
    ds_read_b128 v[172:175], v18 offset:26624
    v_pk_mul_f32 v[224:225], v[224:225], v[4:5] op_sel_hi:[1,0]
    v_pk_mul_f32 v[226:227], v[226:227], v[4:5] op_sel_hi:[1,0]
    v_pk_mul_f32 v[228:229], v[228:229], v[4:5] op_sel_hi:[1,0]
    v_pk_mul_f32 v[230:231], v[230:231], v[4:5] op_sel_hi:[1,0]
    v_pk_mul_f32 v[232:233], v[232:233], v[4:5] op_sel_hi:[1,0]
    v_cvt_pk_bf16_f32 v236, v224, v225
    v_cvt_pk_bf16_f32 v237, v226, v227
    v_cvt_pk_bf16_f32 v238, v228, v229
    v_cvt_pk_bf16_f32 v239, v230, v231
    v_cvt_pk_bf16_f32 v235, v232, v233
    buffer_store_dwordx4 v[236:239], v14, s[28:31], s58 offen sc1
    v_pk_mul_f32 v[240:241], v[240:241], v[4:5] op_sel:[0,1]
    v_pk_mul_f32 v[242:243], v[242:243], v[4:5] op_sel:[0,1]
    v_pk_mul_f32 v[244:245], v[244:245], v[4:5] op_sel:[0,1]
    v_pk_mul_f32 v[246:247], v[246:247], v[4:5] op_sel:[0,1]
    v_pk_mul_f32 v[248:249], v[248:249], v[4:5] op_sel:[0,1]
    v_cvt_pk_bf16_f32 v252, v240, v241
    v_cvt_pk_bf16_f32 v253, v242, v243
    v_cvt_pk_bf16_f32 v254, v244, v245
    v_cvt_pk_bf16_f32 v255, v246, v247
    v_cvt_pk_bf16_f32 v251, v248, v249
    buffer_store_dwordx4 v[252:255], v14, s[28:31], s59 offen sc1
    s_nop 0
    v_permlane32_swap_b32 v235, v251
    buffer_store_dword v235, v15, s[28:31], s5 offen sc1
    v_mov_b32 v6, 163348
    v_mov_b32 v7, 1
    s_setprio 2
    s_mov_b64 exec, 1
    s_waitcnt lgkmcnt(0)
    ds_add_u32 v6, v7
    s_mov_b64 exec, -1
    v_and_b32 v11, 15, v0
    v_lshrrev_b32 v12, 5, v0
    v_bfe_u32 v13, v0, 4, 1
    v_lshlrev_b32 v2, 4, v0
    v_mul_u32_u24 v3, 4608, v12
    v_lshl_add_u32 v3, v13, 8, v3
    v_lshl_add_u32 v3, v11, 2, v3
    v_add_u32 v8, s75, v2
    v_add_u32 v2, s74, v2
    v_lshrrev_b32 v12, 4, v0
    v_mul_u32_u24 v4, 592, v11
    v_lshl_add_u32 v4, v12, 4, v4
    s_cmp_eq_u32 s32, 3
    s_cselect_b32 s40, 4, s32
    s_mul_i32 s40, s40, 18944
    v_add_u32 v4, s40, v4
    v_lshlrev_b32 v9, 3, v0
    v_add_u32 v9, 4096, v9
    v_add_u32 v10, s75, v9
    v_add_u32 v9, s74, v9
    s_lshl_b32 s40, s32, 2
    s_add_u32 s40, s40, 163360
    v_mov_b32 v5, s40
    v_mov_b32 v224, 0
    v_mov_b32 v225, 0
    v_mov_b32 v226, 0
    v_mov_b32 v227, 0
    v_mov_b32 v228, 0
    v_mov_b32 v229, 0
    v_mov_b32 v230, 0
    v_mov_b32 v231, 0
    v_mov_b32 v232, 0
    v_mov_b32 v233, 0
    v_mov_b32 v234, 0
    v_mov_b32 v235, 0
    v_mov_b32 v236, 0
    v_mov_b32 v237, 0
    v_mov_b32 v238, 0
    v_mov_b32 v239, 0
    v_mov_b32 v240, 0
    v_mov_b32 v241, 0
    v_mov_b32 v242, 0
    v_mov_b32 v243, 0
    v_mov_b32 v244, 0
    v_mov_b32 v245, 0
    v_mov_b32 v246, 0
    v_mov_b32 v247, 0
    v_mov_b32 v248, 0
    v_mov_b32 v249, 0
    v_mov_b32 v250, 0
    v_mov_b32 v251, 0
    v_mov_b32 v252, 0
    v_mov_b32 v253, 0
    v_mov_b32 v254, 0
    v_mov_b32 v255, 0
    s_mov_b32 s48, 400000
    s_mov_b32 s46, 4294967295
    s_mov_b32 s42, 0
    s_waitcnt vmcnt(6)
c3_round:
    ds_read_b32 v1, v5
    s_waitcnt lgkmcnt(0)
    v_readfirstlane_b32 s37, v1
    s_andn2_b32 s37, s37, s42
    s_bitcmp1_b32 s37, 0
    s_cbranch_scc0 c3_n0
    ds_read_b128 v[176:179], v2 offset:0
    ds_read_b128 v[180:183], v2 offset:1024
    ds_read_b128 v[184:187], v2 offset:2048
    ds_read_b128 v[188:191], v2 offset:3072
    ds_read_b64 v[192:193], v9 offset:0
    s_waitcnt lgkmcnt(3)
    v_max3_u32 v1, v176, v177, v178
    v_max3_u32 v1, v179, v180, v1
    v_max3_u32 v1, v181, v182, v1
    s_waitcnt lgkmcnt(0)
    v_max3_u32 v1, v183, v184, v1
    v_max3_u32 v1, v185, v186, v1
    v_max3_u32 v1, v187, v188, v1
    v_max3_u32 v1, v189, v190, v1
    v_max3_u32 v1, v191, v192, v1
    v_max_u32 v1, v193, v1
    v_cmp_eq_u32 vcc, s46, v1
    s_nop 1
    s_cbranch_vccnz c3_n0
    s_bitset1_b32 s42, 0
    v_mfma_f32_16x16x32_bf16 v[224:227], v[32:35], v[176:179], v[224:227]
    v_mfma_f32_16x16x32_bf16 v[232:235], v[36:39], v[176:179], v[232:235]
    v_mfma_f32_16x16x32_bf16 v[240:243], v[40:43], v[176:179], v[240:243]
    v_mfma_f32_16x16x32_bf16 v[248:251], v[64:67], v[176:179], v[248:251]
    v_mfma_f32_16x16x32_bf16 v[224:227], v[44:47], v[180:183], v[224:227]
    v_mfma_f32_16x16x32_bf16 v[232:235], v[48:51], v[180:183], v[232:235]
    ds_read_b32 v1, v5
    v_mfma_f32_16x16x32_bf16 v[240:243], v[52:55], v[180:183], v[240:243]
    v_mfma_f32_16x16x32_bf16 v[248:251], v[68:71], v[180:183], v[248:251]
    v_mfma_f32_16x16x32_bf16 v[224:227], v[56:59], v[184:187], v[224:227]
    v_mfma_f32_16x16x32_bf16 v[232:235], v[60:63], v[184:187], v[232:235]
    v_mfma_f32_16x16x32_bf16 v[240:243], v[80:83], v[184:187], v[240:243]
    v_mfma_f32_16x16x32_bf16 v[248:251], v[72:75], v[184:187], v[248:251]
    v_mfma_f32_16x16x32_bf16 v[224:227], v[84:87], v[188:191], v[224:227]
    v_mfma_f32_16x16x32_bf16 v[232:235], v[88:91], v[188:191], v[232:235]
    v_mfma_f32_16x16x32_bf16 v[240:243], v[92:95], v[188:191], v[240:243]
    v_mfma_f32_16x16x32_bf16 v[248:251], v[76:79], v[188:191], v[248:251]
    s_waitcnt lgkmcnt(0)
    v_readfirstlane_b32 s37, v1
    s_andn2_b32 s37, s37, s42
c3_n0:
    s_bitcmp1_b32 s37, 1
    s_cbranch_scc0 c3_n1
    ds_read_b128 v[176:179], v2 offset:4608
    ds_read_b128 v[180:183], v2 offset:5632
    ds_read_b128 v[184:187], v2 offset:6656
    ds_read_b128 v[188:191], v2 offset:7680
    ds_read_b64 v[192:193], v9 offset:4608
    s_waitcnt lgkmcnt(3)
    v_max3_u32 v1, v176, v177, v178
    v_max3_u32 v1, v179, v180, v1
    v_max3_u32 v1, v181, v182, v1
    s_waitcnt lgkmcnt(0)
    v_max3_u32 v1, v183, v184, v1
    v_max3_u32 v1, v185, v186, v1
    v_max3_u32 v1, v187, v188, v1
    v_max3_u32 v1, v189, v190, v1
    v_max3_u32 v1, v191, v192, v1
    v_max_u32 v1, v193, v1
    v_cmp_eq_u32 vcc, s46, v1
    s_nop 1
    s_cbranch_vccnz c3_n1
    s_bitset1_b32 s42, 1
    v_mfma_f32_16x16x32_bf16 v[224:227], v[96:99], v[176:179], v[224:227]
    v_mfma_f32_16x16x32_bf16 v[232:235], v[100:103], v[176:179], v[232:235]
    v_mfma_f32_16x16x32_bf16 v[240:243], v[124:127], v[176:179], v[240:243]
    v_mfma_f32_16x16x32_bf16 v[248:251], v[104:107], v[176:179], v[248:251]
    v_mfma_f32_16x16x32_bf16 v[224:227], v[128:131], v[180:183], v[224:227]
    v_mfma_f32_16x16x32_bf16 v[232:235], v[132:135], v[180:183], v[232:235]
    ds_read_b32 v1, v5
    v_mfma_f32_16x16x32_bf16 v[240:243], v[136:139], v[180:183], v[240:243]
    v_mfma_f32_16x16x32_bf16 v[248:251], v[108:111], v[180:183], v[248:251]
    v_mfma_f32_16x16x32_bf16 v[224:227], v[140:143], v[184:187], v[224:227]
    v_mfma_f32_16x16x32_bf16 v[232:235], v[144:147], v[184:187], v[232:235]
    v_mfma_f32_16x16x32_bf16 v[240:243], v[148:151], v[184:187], v[240:243]
    v_mfma_f32_16x16x32_bf16 v[248:251], v[112:115], v[184:187], v[248:251]
    v_mfma_f32_16x16x32_bf16 v[224:227], v[152:155], v[188:191], v[224:227]
    v_mfma_f32_16x16x32_bf16 v[232:235], v[156:159], v[188:191], v[232:235]
    v_mfma_f32_16x16x32_bf16 v[240:243], v[160:163], v[188:191], v[240:243]
    v_mfma_f32_16x16x32_bf16 v[248:251], v[116:119], v[188:191], v[248:251]
    s_waitcnt lgkmcnt(0)
    v_readfirstlane_b32 s37, v1
    s_andn2_b32 s37, s37, s42
c3_n1:
    s_bitcmp1_b32 s37, 2
    s_cbranch_scc0 c3_n2
    ds_read_b128 v[176:179], v8 offset:0
    ds_read_b128 v[180:183], v8 offset:1024
    ds_read_b128 v[184:187], v8 offset:2048
    ds_read_b128 v[188:191], v8 offset:3072
    ds_read_b64 v[192:193], v10 offset:0
    s_waitcnt lgkmcnt(3)
    v_max3_u32 v1, v176, v177, v178
    v_max3_u32 v1, v179, v180, v1
    v_max3_u32 v1, v181, v182, v1
    s_waitcnt lgkmcnt(0)
    v_max3_u32 v1, v183, v184, v1
    v_max3_u32 v1, v185, v186, v1
    v_max3_u32 v1, v187, v188, v1
    v_max3_u32 v1, v189, v190, v1
    v_max3_u32 v1, v191, v192, v1
    v_max_u32 v1, v193, v1
    v_cmp_eq_u32 vcc, s46, v1
    s_nop 1
    s_cbranch_vccnz c3_n2
    s_bitset1_b32 s42, 2
    v_mfma_f32_16x16x32_bf16 v[228:231], v[32:35], v[176:179], v[228:231]
    v_mfma_f32_16x16x32_bf16 v[236:239], v[36:39], v[176:179], v[236:239]
    v_mfma_f32_16x16x32_bf16 v[244:247], v[40:43], v[176:179], v[244:247]
    v_mfma_f32_16x16x32_bf16 v[252:255], v[64:67], v[176:179], v[252:255]
    v_mfma_f32_16x16x32_bf16 v[228:231], v[44:47], v[180:183], v[228:231]
    v_mfma_f32_16x16x32_bf16 v[236:239], v[48:51], v[180:183], v[236:239]
    ds_read_b32 v1, v5
    v_mfma_f32_16x16x32_bf16 v[244:247], v[52:55], v[180:183], v[244:247]
    v_mfma_f32_16x16x32_bf16 v[252:255], v[68:71], v[180:183], v[252:255]
    v_mfma_f32_16x16x32_bf16 v[228:231], v[56:59], v[184:187], v[228:231]
    v_mfma_f32_16x16x32_bf16 v[236:239], v[60:63], v[184:187], v[236:239]
    v_mfma_f32_16x16x32_bf16 v[244:247], v[80:83], v[184:187], v[244:247]
    v_mfma_f32_16x16x32_bf16 v[252:255], v[72:75], v[184:187], v[252:255]
    v_mfma_f32_16x16x32_bf16 v[228:231], v[84:87], v[188:191], v[228:231]
    v_mfma_f32_16x16x32_bf16 v[236:239], v[88:91], v[188:191], v[236:239]
    v_mfma_f32_16x16x32_bf16 v[244:247], v[92:95], v[188:191], v[244:247]
    v_mfma_f32_16x16x32_bf16 v[252:255], v[76:79], v[188:191], v[252:255]
    s_waitcnt lgkmcnt(0)
    v_readfirstlane_b32 s37, v1
    s_andn2_b32 s37, s37, s42
c3_n2:
    s_bitcmp1_b32 s37, 3
    s_cbranch_scc0 c3_n3
    ds_read_b128 v[176:179], v8 offset:4608
    ds_read_b128 v[180:183], v8 offset:5632
    ds_read_b128 v[184:187], v8 offset:6656
    ds_read_b128 v[188:191], v8 offset:7680
    ds_read_b64 v[192:193], v10 offset:4608
    s_waitcnt lgkmcnt(3)
    v_max3_u32 v1, v176, v177, v178
    v_max3_u32 v1, v179, v180, v1
    v_max3_u32 v1, v181, v182, v1
    s_waitcnt lgkmcnt(0)
    v_max3_u32 v1, v183, v184, v1
    v_max3_u32 v1, v185, v186, v1
    v_max3_u32 v1, v187, v188, v1
    v_max3_u32 v1, v189, v190, v1
    v_max3_u32 v1, v191, v192, v1
    v_max_u32 v1, v193, v1
    v_cmp_eq_u32 vcc, s46, v1
    s_nop 1
    s_cbranch_vccnz c3_n3
    s_bitset1_b32 s42, 3
    v_mfma_f32_16x16x32_bf16 v[228:231], v[96:99], v[176:179], v[228:231]
    v_mfma_f32_16x16x32_bf16 v[236:239], v[100:103], v[176:179], v[236:239]
    v_mfma_f32_16x16x32_bf16 v[244:247], v[124:127], v[176:179], v[244:247]
    v_mfma_f32_16x16x32_bf16 v[252:255], v[104:107], v[176:179], v[252:255]
    v_mfma_f32_16x16x32_bf16 v[228:231], v[128:131], v[180:183], v[228:231]
    v_mfma_f32_16x16x32_bf16 v[236:239], v[132:135], v[180:183], v[236:239]
    v_mfma_f32_16x16x32_bf16 v[244:247], v[136:139], v[180:183], v[244:247]
    v_mfma_f32_16x16x32_bf16 v[252:255], v[108:111], v[180:183], v[252:255]
    v_mfma_f32_16x16x32_bf16 v[228:231], v[140:143], v[184:187], v[228:231]
    v_mfma_f32_16x16x32_bf16 v[236:239], v[144:147], v[184:187], v[236:239]
    v_mfma_f32_16x16x32_bf16 v[244:247], v[148:151], v[184:187], v[244:247]
    v_mfma_f32_16x16x32_bf16 v[252:255], v[112:115], v[184:187], v[252:255]
    v_mfma_f32_16x16x32_bf16 v[228:231], v[152:155], v[188:191], v[228:231]
    v_mfma_f32_16x16x32_bf16 v[236:239], v[156:159], v[188:191], v[236:239]
    v_mfma_f32_16x16x32_bf16 v[244:247], v[160:163], v[188:191], v[244:247]
    v_mfma_f32_16x16x32_bf16 v[252:255], v[116:119], v[188:191], v[252:255]
c3_n3:
    s_cmp_eq_u32 s42, 15
    s_cbranch_scc1 c3_done
    s_sub_u32 s48, s48, 1
    s_cmp_lt_i32 s48, 0
    s_cbranch_scc0 c3_round
c3_done:
    v_add_u32 v1, s74, v3
    ds_read_b32 v176, v1 offset:4096
    ds_read_b32 v177, v1 offset:4160
    ds_read_b32 v178, v1 offset:4224
    ds_read_b32 v179, v1 offset:4288
    v_add_u32 v1, s75, v3
    ds_read_b32 v180, v1 offset:4096
    ds_read_b32 v181, v1 offset:4160
    ds_read_b32 v182, v1 offset:4224
    ds_read_b32 v183, v1 offset:4288
    s_lshl_b32 s40, s49, 6
    v_add_u32 v1, s40, v0
    s_and_b32 s37, s88, 60
    s_add_u32 s37, s37, s88
    s_mul_i32 s37, s37, 18432
    s_mul_i32 s38, s89, 288
    s_add_u32 s37, s37, s38
    v_mul_u32_u24 v38, 3641, v1
    v_lshrrev_b32 v38, 16, v38
    v_mul_u32_u24 v39, 18, v38
    v_sub_u32 v39, v1, v39
    v_mul_u32_u24 v32, 592, v38
    v_lshl_add_u32 v32, v39, 5, v32
    v_add_u32 v36, 75776, v32
    v_and_b32 v34, 16, v38
    v_mad_u32_u24 v38, v34, 3, v38
    v_mul_u32_u24 v34, 1152, v38
    v_lshl_add_u32 v34, v39, 4, v34
    v_add_u32 v1, 512, v1
    v_mul_u32_u24 v38, 3641, v1
    v_lshrrev_b32 v38, 16, v38
    v_mul_u32_u24 v39, 18, v38
    v_sub_u32 v39, v1, v39
    v_mul_u32_u24 v33, 592, v38
    v_lshl_add_u32 v33, v39, 5, v33
    v_add_u32 v37, 75776, v33
    v_and_b32 v35, 16, v38
    v_mad_u32_u24 v38, v35, 3, v38
    v_mul_u32_u24 v35, 1152, v38
    v_lshl_add_u32 v35, v39, 4, v35
    s_waitcnt lgkmcnt(0)
    v_mfma_f32_16x16x32_bf16 v[224:227], v[164:167], v[176:179], v[224:227]
    v_mfma_f32_16x16x32_bf16 v[228:231], v[164:167], v[180:183], v[228:231]
    v_mfma_f32_16x16x32_bf16 v[232:235], v[168:171], v[176:179], v[232:235]
    v_mfma_f32_16x16x32_bf16 v[236:239], v[168:171], v[180:183], v[236:239]
    v_mfma_f32_16x16x32_bf16 v[240:243], v[172:175], v[176:179], v[240:243]
    v_mfma_f32_16x16x32_bf16 v[244:247], v[172:175], v[180:183], v[244:247]
    v_mfma_f32_16x16x32_bf16 v[248:251], v[120:123], v[176:179], v[248:251]
    v_mfma_f32_16x16x32_bf16 v[252:255], v[120:123], v[180:183], v[252:255]
    s_nop 7
    ds_write_b128 v4, v[224:227] offset:320
    ds_write_b128 v4, v[228:231] offset:9792
    ds_write_b128 v4, v[232:235] offset:384
    ds_write_b128 v4, v[236:239] offset:9856
    ds_write_b128 v4, v[240:243] offset:448
    ds_write_b128 v4, v[244:247] offset:9920
    ds_write_b128 v4, v[248:251] offset:512
    ds_write_b128 v4, v[252:255] offset:9984
k_final:
    s_cmp_eq_u32 s49, 0
    s_waitcnt lgkmcnt(0)
    s_barrier
    ds_read_b128 v[48:51], v32 offset:0
    ds_read_b128 v[52:55], v32 offset:16
    ds_read_b128 v[56:59], v32 offset:18944
    ds_read_b128 v[60:63], v32 offset:18960
    ds_read_b128 v[64:67], v32 offset:37888
    ds_read_b128 v[68:71], v32 offset:37904
    ds_read_b128 v[72:75], v36 offset:0
    ds_read_b128 v[76:79], v36 offset:16
    s_cbranch_scc1 k_fin0
    s_waitcnt lgkmcnt(4)
    v_pk_add_f32 v[48:49], v[48:49], v[56:57]
    v_pk_add_f32 v[50:51], v[50:51], v[58:59]
    v_pk_add_f32 v[52:53], v[52:53], v[60:61]
    v_pk_add_f32 v[54:55], v[54:55], v[62:63]
    s_waitcnt lgkmcnt(0)
    v_pk_add_f32 v[64:65], v[64:65], v[72:73]
    v_pk_add_f32 v[66:67], v[66:67], v[74:75]
    v_pk_add_f32 v[68:69], v[68:69], v[76:77]
    v_pk_add_f32 v[70:71], v[70:71], v[78:79]
    v_pk_add_f32 v[48:49], v[48:49], v[64:65]
    v_pk_add_f32 v[50:51], v[50:51], v[66:67]
    v_pk_add_f32 v[52:53], v[52:53], v[68:69]
    v_pk_add_f32 v[54:55], v[54:55], v[70:71]
    v_cvt_pk_bf16_f32 v56, v48, v49
    v_cvt_pk_bf16_f32 v57, v50, v51
    v_cvt_pk_bf16_f32 v58, v52, v53
    v_cvt_pk_bf16_f32 v59, v54, v55
    buffer_store_dwordx4 v[56:59], v34, s[84:87], s37 offen
    s_endpgm
k_fin0:
    ds_read_b128 v[80:83], v33 offset:0
    ds_read_b128 v[84:87], v33 offset:16
    ds_read_b128 v[88:91], v33 offset:18944
    ds_read_b128 v[92:95], v33 offset:18960
    ds_read_b128 v[96:99], v33 offset:37888
    ds_read_b128 v[100:103], v33 offset:37904
    ds_read_b128 v[104:107], v37 offset:0
    ds_read_b128 v[108:111], v37 offset:16
    s_waitcnt lgkmcnt(12)
    v_pk_add_f32 v[48:49], v[48:49], v[56:57]
    v_pk_add_f32 v[50:51], v[50:51], v[58:59]
    v_pk_add_f32 v[52:53], v[52:53], v[60:61]
    v_pk_add_f32 v[54:55], v[54:55], v[62:63]
    s_waitcnt lgkmcnt(8)
    v_pk_add_f32 v[64:65], v[64:65], v[72:73]
    v_pk_add_f32 v[66:67], v[66:67], v[74:75]
    v_pk_add_f32 v[68:69], v[68:69], v[76:77]
    v_pk_add_f32 v[70:71], v[70:71], v[78:79]
    v_pk_add_f32 v[48:49], v[48:49], v[64:65]
    v_pk_add_f32 v[50:51], v[50:51], v[66:67]
    v_pk_add_f32 v[52:53], v[52:53], v[68:69]
    v_pk_add_f32 v[54:55], v[54:55], v[70:71]
    v_cvt_pk_bf16_f32 v56, v48, v49
    v_cvt_pk_bf16_f32 v57, v50, v51
    v_cvt_pk_bf16_f32 v58, v52, v53
    v_cvt_pk_bf16_f32 v59, v54, v55
    buffer_store_dwordx4 v[56:59], v34, s[84:87], s37 offen
    s_waitcnt lgkmcnt(4)
    v_pk_add_f32 v[80:81], v[80:81], v[88:89]
    v_pk_add_f32 v[82:83], v[82:83], v[90:91]
    v_pk_add_f32 v[84:85], v[84:85], v[92:93]
    v_pk_add_f32 v[86:87], v[86:87], v[94:95]
    s_waitcnt lgkmcnt(0)
    v_pk_add_f32 v[96:97], v[96:97], v[104:105]
    v_pk_add_f32 v[98:99], v[98:99], v[106:107]
    v_pk_add_f32 v[100:101], v[100:101], v[108:109]
    v_pk_add_f32 v[102:103], v[102:103], v[110:111]
    v_pk_add_f32 v[80:81], v[80:81], v[96:97]
    v_pk_add_f32 v[82:83], v[82:83], v[98:99]
    v_pk_add_f32 v[84:85], v[84:85], v[100:101]
    v_pk_add_f32 v[86:87], v[86:87], v[102:103]
    v_cvt_pk_bf16_f32 v88, v80, v81
    v_cvt_pk_bf16_f32 v89, v82, v83
    v_cvt_pk_bf16_f32 v90, v84, v85
    v_cvt_pk_bf16_f32 v91, v86, v87
    buffer_store_dwordx4 v[88:91], v35, s[84:87], s37 offen
k_end:
    s_endpgm
k_rst:
    s_lshl_b32 s37, s33, 2
    v_mov_b32 v28, s37
    v_mov_b32 v29, 1
    s_mov_b64 exec, 1
    s_waitcnt vmcnt(0)
    buffer_atomic_add v29, v28, s[24:27], 0 offen
    s_mov_b64 exec, -1
    s_branch k_rst_ret
k_hook1:
    s_barrier
    s_branch k_hook_ret1
k_fbchk:
    s_mov_b32 s64, 0x53800000
    s_cmp_lg_u32 s7, 0
    s_cbranch_scc1 k_fbc2
    v_cmp_le_f32 vcc, s61, v202
    v_cmp_ge_f32 s[52:53], s64, v202
    s_nop 1
    s_and_b32 vcc_lo, vcc_lo, s52
    s_cmp_eq_u32 vcc_lo, -1
    s_cbranch_scc0 k_fb0
k_fbret0:
    v_cmp_le_f32 vcc, s61, v218
    v_cmp_ge_f32 s[52:53], s64, v218
    s_nop 1
    s_and_b32 vcc_lo, vcc_lo, s52
    s_cmp_eq_u32 vcc_lo, -1
    s_cbranch_scc0 k_fb1
k_fbret1:
    v_mov_b32 v2, v202
    v_mov_b32 v3, v218
    s_nop 0
    v_permlane32_swap_b32 v202, v2
    v_permlane32_swap_b32 v218, v3
    v_fma_f32 v2, v202, v26, v202
    v_fma_f32 v3, v218, v27, v218
    v_rcp_f32 v2, v2
    v_rcp_f32 v3, v3
    s_nop 0
    v_pk_mul_f32 v[192:193], v[192:193], v[2:3] op_sel_hi:[1,0]
    v_pk_mul_f32 v[194:195], v[194:195], v[2:3] op_sel_hi:[1,0]
    v_pk_mul_f32 v[196:197], v[196:197], v[2:3] op_sel_hi:[1,0]
    v_pk_mul_f32 v[198:199], v[198:199], v[2:3] op_sel_hi:[1,0]
    v_pk_mul_f32 v[200:201], v[200:201], v[2:3] op_sel_hi:[1,0]
    v_cvt_pk_bf16_f32 v204, v192, v193
    v_cvt_pk_bf16_f32 v205, v194, v195
    v_cvt_pk_bf16_f32 v206, v196, v197
    v_cvt_pk_bf16_f32 v207, v198, v199
    v_cvt_pk_bf16_f32 v203, v200, v201
    buffer_store_dwordx4 v[204:207], v14, s[28:31], s56 offen sc1
    v_pk_mul_f32 v[208:209], v[208:209], v[2:3] op_sel:[0,1]
    v_pk_mul_f32 v[210:211], v[210:211], v[2:3] op_sel:[0,1]
    v_pk_mul_f32 v[212:213], v[212:213], v[2:3] op_sel:[0,1]
    v_pk_mul_f32 v[214:215], v[214:215], v[2:3] op_sel:[0,1]
    v_pk_mul_f32 v[216:217], v[216:217], v[2:3] op_sel:[0,1]
    v_cvt_pk_bf16_f32 v220, v208, v209
    v_cvt_pk_bf16_f32 v221, v210, v211
    v_cvt_pk_bf16_f32 v222, v212, v213
    v_cvt_pk_bf16_f32 v223, v214, v215
    v_cvt_pk_bf16_f32 v219, v216, v217
    buffer_store_dwordx4 v[220:223], v14, s[28:31], s57 offen sc1
    s_nop 0
    v_permlane32_swap_b32 v203, v219
    buffer_store_dword v203, v15, s[28:31], s4 offen sc1
k_fbc2:
    v_cmp_le_f32 vcc, s61, v234
    v_cmp_ge_f32 s[52:53], s64, v234
    s_nop 1
    s_and_b32 vcc_lo, vcc_lo, s52
    s_cmp_eq_u32 vcc_lo, -1
    s_cbranch_scc0 k_fb2
k_fbret2:
    v_cmp_le_f32 vcc, s61, v250
    v_cmp_ge_f32 s[52:53], s64, v250
    s_nop 1
    s_and_b32 vcc_lo, vcc_lo, s52
    s_cmp_eq_u32 vcc_lo, -1
    s_cbranch_scc0 k_fb3
k_fbret3:
    s_branch k_fbdone
k_fb0:
    v_mov_b32 v176, v32
    v_mov_b32 v177, v33
    v_mov_b32 v178, v34
    v_mov_b32 v179, v35
    v_mov_b32 v180, 0
    v_mov_b32 v181, 0
    v_mov_b32 v182, 0
    v_mov_b32 v183, 0
    s_mov_b32 exec_hi, 0
    v_mov_b32 v180, v48
    v_mov_b32 v183, v48
    s_mov_b64 exec, -1
    s_call_b64 s[50:51], k_slow
    v_mov_b32 v192, v160
    v_mov_b32 v193, v161
    v_mov_b32 v194, v162
    v_mov_b32 v195, v163
    v_mov_b32 v196, v164
    v_mov_b32 v197, v165
    v_mov_b32 v198, v166
    v_mov_b32 v199, v167
    v_mov_b32 v200, v168
    v_mov_b32 v201, v169
    v_mov_b32 v202, v170
    v_mov_b32 v203, v171
    v_mov_b32 v204, v172
    v_mov_b32 v205, v173
    v_mov_b32 v206, v174
    v_mov_b32 v207, v175
    s_branch k_fbret0
k_fb1:
    v_mov_b32 v176, v36
    v_mov_b32 v177, v37
    v_mov_b32 v178, v38
    v_mov_b32 v179, v39
    v_mov_b32 v180, 0
    v_mov_b32 v181, 0
    v_mov_b32 v182, 0
    v_mov_b32 v183, 0
    s_mov_b32 exec_lo, 0
    v_mov_b32 v180, v48
    v_mov_b32 v183, v48
    s_mov_b64 exec, -1
    s_call_b64 s[50:51], k_slow
    v_mov_b32 v208, v160
    v_mov_b32 v209, v161
    v_mov_b32 v210, v162
    v_mov_b32 v211, v163
    v_mov_b32 v212, v164
    v_mov_b32 v213, v165
    v_mov_b32 v214, v166
    v_mov_b32 v215, v167
    v_mov_b32 v216, v168
    v_mov_b32 v217, v169
    v_mov_b32 v218, v170
    v_mov_b32 v219, v171
    v_mov_b32 v220, v172
    v_mov_b32 v221, v173
    v_mov_b32 v222, v174
    v_mov_b32 v223, v175
    s_branch k_fbret1
k_fb2:
    v_mov_b32 v176, v40
    v_mov_b32 v177, v41
    v_mov_b32 v178, v42
    v_mov_b32 v179, v43
    v_mov_b32 v180, 0
    v_mov_b32 v181, 0
    v_mov_b32 v182, 0
    v_mov_b32 v183, 0
    s_mov_b32 exec_hi, 0
    v_mov_b32 v180, v52
    v_mov_b32 v183, v52
    s_mov_b64 exec, -1
    s_call_b64 s[50:51], k_slow
    v_mov_b32 v224, v160
    v_mov_b32 v225, v161
    v_mov_b32 v226, v162
    v_mov_b32 v227, v163
    v_mov_b32 v228, v164
    v_mov_b32 v229, v165
    v_mov_b32 v230, v166
    v_mov_b32 v231, v167
    v_mov_b32 v232, v168
    v_mov_b32 v233, v169
    v_mov_b32 v234, v170
    v_mov_b32 v235, v171
    v_mov_b32 v236, v172
    v_mov_b32 v237, v173
    v_mov_b32 v238, v174
    v_mov_b32 v239, v175
    s_branch k_fbret2
k_fb3:
    v_mov_b32 v176, v44
    v_mov_b32 v177, v45
    v_mov_b32 v178, v46
    v_mov_b32 v179, v47
    v_mov_b32 v180, 0
    v_mov_b32 v181, 0
    v_mov_b32 v182, 0
    v_mov_b32 v183, 0
    s_mov_b32 exec_lo, 0
    v_mov_b32 v180, v52
    v_mov_b32 v183, v52
    s_mov_b64 exec, -1
    s_call_b64 s[50:51], k_slow
    v_mov_b32 v240, v160
    v_mov_b32 v241, v161
    v_mov_b32 v242, v162
    v_mov_b32 v243, v163
    v_mov_b32 v244, v164
    v_mov_b32 v245, v165
    v_mov_b32 v246, v166
    v_mov_b32 v247, v167
    v_mov_b32 v248, v168
    v_mov_b32 v249, v169
    v_mov_b32 v250, v170
    v_mov_b32 v251, v171
    v_mov_b32 v252, v172
    v_mov_b32 v253, v173
    v_mov_b32 v254, v174
    v_mov_b32 v255, v175
    s_branch k_fbret3
k_slow:
    v_lshlrev_b32 v9, 4, v0
    v_and_b32 v13, 31, v0
    v_lshlrev_b32 v11, 4, v13
    v_lshrrev_b32 v12, 5, v0
    v_mul_u32_u24 v12, 304, v12
    v_lshl_add_u32 v12, v13, 4, v12
    v_cmp_lt_u32 vcc, 18, v13
    v_mov_b32 v13, 0x40000000
    s_nop 1
    v_cndmask_b32 v12, v12, v13, vcc
    v_mov_b32 v13, 0xff800000
    s_mov_b32 s54, s47
    s_mov_b32 s46, 16
k_sl1:
    s_add_u32 s55, s54, 4096
    buffer_load_dwordx4 v[56:59], v11, s[28:31], s55 offen sc1
    buffer_load_dwordx4 v[80:83], v9, s[28:31], s54 offen offset:0 sc1
    s_waitcnt vmcnt(0)
    v_mfma_f32_32x32x16_bf16 v[128:143], v[80:83], v[176:179], 0
    v_mfma_f32_32x32x8_bf16 v[128:143], v[56:57], v[180:181], v[128:143]
    s_nop 15
    v_max3_f32 v13, v128, v129, v13
    v_max3_f32 v13, v130, v131, v13
    v_max3_f32 v13, v132, v133, v13
    v_max3_f32 v13, v134, v135, v13
    v_max3_f32 v13, v136, v137, v13
    v_max3_f32 v13, v138, v139, v13
    v_max3_f32 v13, v140, v141, v13
    v_max3_f32 v13, v142, v143, v13
    buffer_load_dwordx4 v[80:83], v9, s[28:31], s54 offen offset:1024 sc1
    s_waitcnt vmcnt(0)
    v_mfma_f32_32x32x16_bf16 v[128:143], v[80:83], v[176:179], 0
    v_mfma_f32_32x32x8_bf16 v[128:143], v[56:57], v[182:183], v[128:143]
    s_nop 15
    v_max3_f32 v13, v128, v129, v13
    v_max3_f32 v13, v130, v131, v13
    v_max3_f32 v13, v132, v133, v13
    v_max3_f32 v13, v134, v135, v13
    v_max3_f32 v13, v136, v137, v13
    v_max3_f32 v13, v138, v139, v13
    v_max3_f32 v13, v140, v141, v13
    v_max3_f32 v13, v142, v143, v13
    buffer_load_dwordx4 v[80:83], v9, s[28:31], s54 offen offset:2048 sc1
    s_waitcnt vmcnt(0)
    v_mfma_f32_32x32x16_bf16 v[128:143], v[80:83], v[176:179], 0
    v_mfma_f32_32x32x8_bf16 v[128:143], v[58:59], v[180:181], v[128:143]
    s_nop 15
    v_max3_f32 v13, v128, v129, v13
    v_max3_f32 v13, v130, v131, v13
    v_max3_f32 v13, v132, v133, v13
    v_max3_f32 v13, v134, v135, v13
    v_max3_f32 v13, v136, v137, v13
    v_max3_f32 v13, v138, v139, v13
    v_max3_f32 v13, v140, v141, v13
    v_max3_f32 v13, v142, v143, v13
    buffer_load_dwordx4 v[80:83], v9, s[28:31], s54 offen offset:3072 sc1
    s_waitcnt vmcnt(0)
    v_mfma_f32_32x32x16_bf16 v[128:143], v[80:83], v[176:179], 0
    v_mfma_f32_32x32x8_bf16 v[128:143], v[58:59], v[182:183], v[128:143]
    s_nop 15
    v_max3_f32 v13, v128, v129, v13
    v_max3_f32 v13, v130, v131, v13
    v_max3_f32 v13, v132, v133, v13
    v_max3_f32 v13, v134, v135, v13
    v_max3_f32 v13, v136, v137, v13
    v_max3_f32 v13, v138, v139, v13
    v_max3_f32 v13, v140, v141, v13
    v_max3_f32 v13, v142, v143, v13
    s_add_u32 s54, s54, 9472
    s_sub_u32 s46, s46, 1
    s_cmp_lg_u32 s46, 0
    s_cbranch_scc1 k_sl1
    v_mov_b32 v128, v13
    s_nop 1
    v_permlane32_swap_b32 v13, v128
    s_nop 1
    v_max_f32 v13, v13, v128
    v_sub_f32 v144, 0, v13
    v_mov_b32 v160, 0
    v_sub_f32 v145, 0, v13
    v_mov_b32 v161, 0
    v_sub_f32 v146, 0, v13
    v_mov_b32 v162, 0
    v_sub_f32 v147, 0, v13
    v_mov_b32 v163, 0
    v_sub_f32 v148, 0, v13
    v_mov_b32 v164, 0
    v_sub_f32 v149, 0, v13
    v_mov_b32 v165, 0
    v_sub_f32 v150, 0, v13
    v_mov_b32 v166, 0
    v_sub_f32 v151, 0, v13
    v_mov_b32 v167, 0
    v_sub_f32 v152, 0, v13
    v_mov_b32 v168, 0
    v_sub_f32 v153, 0, v13
    v_mov_b32 v169, 0
    v_sub_f32 v154, 0, v13
    v_mov_b32 v170, 0
    v_sub_f32 v155, 0, v13
    v_mov_b32 v171, 0
    v_sub_f32 v156, 0, v13
    v_mov_b32 v172, 0
    v_sub_f32 v157, 0, v13
    v_mov_b32 v173, 0
    v_sub_f32 v158, 0, v13
    v_mov_b32 v174, 0
    v_sub_f32 v159, 0, v13
    v_mov_b32 v175, 0
    s_mov_b32 s54, s47
    s_mov_b32 s46, 16
k_sl2:
    s_add_u32 s55, s54, 4096
    buffer_load_dwordx4 v[56:59], v11, s[28:31], s55 offen sc1
    buffer_load_dwordx4 v[80:83], v9, s[28:31], s54 offen offset:0 sc1
    s_add_u32 s55, s54, 4608
    buffer_load_dwordx4 v[88:91], v12, s[28:31], s55 offen sc1
    buffer_load_dwordx4 v[96:99], v12, s[28:31], s55 offen offset:608 sc1
    s_waitcnt vmcnt(0)
    v_mfma_f32_32x32x16_bf16 v[128:143], v[80:83], v[176:179], v[144:159]
    v_mfma_f32_32x32x8_bf16 v[128:143], v[56:57], v[180:181], v[128:143]
    s_nop 15
    v_exp_f32 v128, v128
    v_exp_f32 v129, v129
    v_exp_f32 v130, v130
    v_exp_f32 v131, v131
    v_exp_f32 v132, v132
    v_exp_f32 v133, v133
    v_exp_f32 v134, v134
    v_exp_f32 v135, v135
    v_exp_f32 v136, v136
    v_exp_f32 v137, v137
    v_exp_f32 v138, v138
    v_exp_f32 v139, v139
    v_exp_f32 v140, v140
    v_exp_f32 v141, v141
    v_exp_f32 v142, v142
    v_exp_f32 v143, v143
    s_nop 3
    v_smfmac_f32_32x32x32_bf16 v[160:175], v[88:91], v[128:135], v10
    v_smfmac_f32_32x32x32_bf16 v[160:175], v[96:99], v[136:143], v10
    s_nop 7
    buffer_load_dwordx4 v[80:83], v9, s[28:31], s54 offen offset:1024 sc1
    s_add_u32 s55, s54, 5824
    buffer_load_dwordx4 v[88:91], v12, s[28:31], s55 offen sc1
    buffer_load_dwordx4 v[96:99], v12, s[28:31], s55 offen offset:608 sc1
    s_waitcnt vmcnt(0)
    v_mfma_f32_32x32x16_bf16 v[128:143], v[80:83], v[176:179], v[144:159]
    v_mfma_f32_32x32x8_bf16 v[128:143], v[56:57], v[182:183], v[128:143]
    s_nop 15
    v_exp_f32 v128, v128
    v_exp_f32 v129, v129
    v_exp_f32 v130, v130
    v_exp_f32 v131, v131
    v_exp_f32 v132, v132
    v_exp_f32 v133, v133
    v_exp_f32 v134, v134
    v_exp_f32 v135, v135
    v_exp_f32 v136, v136
    v_exp_f32 v137, v137
    v_exp_f32 v138, v138
    v_exp_f32 v139, v139
    v_exp_f32 v140, v140
    v_exp_f32 v141, v141
    v_exp_f32 v142, v142
    v_exp_f32 v143, v143
    s_nop 3
    v_smfmac_f32_32x32x32_bf16 v[160:175], v[88:91], v[128:135], v10
    v_smfmac_f32_32x32x32_bf16 v[160:175], v[96:99], v[136:143], v10
    s_nop 7
    buffer_load_dwordx4 v[80:83], v9, s[28:31], s54 offen offset:2048 sc1
    s_add_u32 s55, s54, 7040
    buffer_load_dwordx4 v[88:91], v12, s[28:31], s55 offen sc1
    buffer_load_dwordx4 v[96:99], v12, s[28:31], s55 offen offset:608 sc1
    s_waitcnt vmcnt(0)
    v_mfma_f32_32x32x16_bf16 v[128:143], v[80:83], v[176:179], v[144:159]
    v_mfma_f32_32x32x8_bf16 v[128:143], v[58:59], v[180:181], v[128:143]
    s_nop 15
    v_exp_f32 v128, v128
    v_exp_f32 v129, v129
    v_exp_f32 v130, v130
    v_exp_f32 v131, v131
    v_exp_f32 v132, v132
    v_exp_f32 v133, v133
    v_exp_f32 v134, v134
    v_exp_f32 v135, v135
    v_exp_f32 v136, v136
    v_exp_f32 v137, v137
    v_exp_f32 v138, v138
    v_exp_f32 v139, v139
    v_exp_f32 v140, v140
    v_exp_f32 v141, v141
    v_exp_f32 v142, v142
    v_exp_f32 v143, v143
    s_nop 3
    v_smfmac_f32_32x32x32_bf16 v[160:175], v[88:91], v[128:135], v10
    v_smfmac_f32_32x32x32_bf16 v[160:175], v[96:99], v[136:143], v10
    s_nop 7
    buffer_load_dwordx4 v[80:83], v9, s[28:31], s54 offen offset:3072 sc1
    s_add_u32 s55, s54, 8256
    buffer_load_dwordx4 v[88:91], v12, s[28:31], s55 offen sc1
    buffer_load_dwordx4 v[96:99], v12, s[28:31], s55 offen offset:608 sc1
    s_waitcnt vmcnt(0)
    v_mfma_f32_32x32x16_bf16 v[128:143], v[80:83], v[176:179], v[144:159]
    v_mfma_f32_32x32x8_bf16 v[128:143], v[58:59], v[182:183], v[128:143]
    s_nop 15
    v_exp_f32 v128, v128
    v_exp_f32 v129, v129
    v_exp_f32 v130, v130
    v_exp_f32 v131, v131
    v_exp_f32 v132, v132
    v_exp_f32 v133, v133
    v_exp_f32 v134, v134
    v_exp_f32 v135, v135
    v_exp_f32 v136, v136
    v_exp_f32 v137, v137
    v_exp_f32 v138, v138
    v_exp_f32 v139, v139
    v_exp_f32 v140, v140
    v_exp_f32 v141, v141
    v_exp_f32 v142, v142
    v_exp_f32 v143, v143
    s_nop 3
    v_smfmac_f32_32x32x32_bf16 v[160:175], v[88:91], v[128:135], v10
    v_smfmac_f32_32x32x32_bf16 v[160:175], v[96:99], v[136:143], v10
    s_nop 7
    s_add_u32 s54, s54, 9472
    s_sub_u32 s46, s46, 1
    s_cmp_lg_u32 s46, 0
    s_cbranch_scc1 k_sl2
    s_nop 15
    s_setpc_b64 s[50:51]
.section .rodata,"a"
.p2align 6
.amdhsa_kernel gated_mix__mha_block__mha_block__prompt_kernel
  .amdhsa_next_free_vgpr 256
  .amdhsa_next_free_sgpr 102
  .amdhsa_accum_offset 256
  .amdhsa_group_segment_fixed_size 0
  .amdhsa_kernarg_size 80
  .amdhsa_user_sgpr_count 2
  .amdhsa_user_sgpr_kernarg_segment_ptr 1
  .amdhsa_system_sgpr_workgroup_id_x 1
.end_amdhsa_kernel
```
